```python
import torch

def _softmax(x, axis=-1):
    return torch.softmax(x, dim=axis)
def _gelu(x):
    return torch.nn.functional.gelu(x, approximate="tanh")
def _silu(x):
    return torch.nn.functional.silu(x)
def _sigmoid(x):
    return torch.sigmoid(x)
def _layernorm(x, axis=-1, eps=1e-5):
    m = x.mean(dim=axis, keepdim=True)
    v = x.var(dim=axis, keepdim=True, unbiased=False)
    return (x - m) / torch.sqrt(v + eps)
def _scatter_add(tgt, idx, src, axis=0):
    return tgt.clone().index_add_(axis, idx, src)
def _segment_sum(src, seg, n):
    out = torch.zeros((n,) + src.shape[1:], dtype=src.dtype)
    return out.index_add_(0, seg, src)
def _pad(x, pw):
    flat = tuple(v for pair in reversed(pw) for v in pair)
    return torch.nn.functional.pad(x, flat)

kernel_name = 'gated_mix__softmax_full_mha__grouped_kv_mqa__prompt'

def setup_inputs():

    _w = (lambda a: (lambda t: t.to(torch.bfloat16) if t.is_floating_point() else t)(torch.as_tensor(a)))
    def _A_setup():
        B, S, D = 1, 2048, 512
        return {
            "x": _w((lambda *s: torch.randn(*s, dtype=torch.bfloat16) * 0.05)(B, S, D)),
            "wqkv": _w((lambda *s: torch.randn(*s, dtype=torch.bfloat16) * 3.2)(D, 3 * D)),
            "wo": _w((lambda *s: torch.randn(*s, dtype=torch.bfloat16) * 1.6)(D, D)),
        }
    _A_in = _A_setup()

    def _B_setup():
        B, S, D, H = 1, 2048, 512, 32
        Dh = D // H
        return {
            "x": _w((lambda *s: torch.randn(*s, dtype=torch.bfloat16) * 0.05)(B, S, D)),
            "wq": _w((lambda *s: torch.randn(*s, dtype=torch.bfloat16) * 3.2)(D, H * Dh)),
            "wk": _w((lambda *s: torch.randn(*s, dtype=torch.bfloat16) * 3.2)(D, Dh)),
            "wv": _w((lambda *s: torch.randn(*s, dtype=torch.bfloat16) * 1.6)(D, Dh)),
            "wo": _w((lambda *s: torch.randn(*s, dtype=torch.bfloat16) * 1.6)(H * Dh, D)),
        }
    _B_in = _B_setup()

    return {
        "A_x": _A_in["x"],
        "A_wqkv": _A_in["wqkv"],
        "A_wo": _A_in["wo"],
        "B_x": _B_in["x"],
        "B_wq": _B_in["wq"],
        "B_wk": _B_in["wk"],
        "B_wv": _B_in["wv"],
        "B_wo": _B_in["wo"],
        "gate_w": _w((lambda *s: torch.randn(*s, dtype=torch.bfloat16) * 0.05)(512) * 16.0),
    }

def reference(A_x, A_wqkv, A_wo, B_x, B_wq, B_wk, B_wv, B_wo, gate_w):
    def _A_ref(x, wqkv, wo):
        B, S, D = x.shape
        H = 32; Dh = D // H
        qkv = (lambda x, *d: x.permute(*d))((x @ wqkv).reshape(B, S, 3, H, Dh), 2, 0, 3, 1, 4)
        q, k, v = qkv[0], qkv[1], qkv[2]
        scale = Dh ** -0.5
        scores = torch.einsum("bhqd,bhkd->bhqk", q, k) * scale
        p = _softmax(scores, axis=-1)
        o = torch.einsum("bhqk,bhkd->bhqd", p, v)
        return (lambda x, *d: x.permute(*d))(o, 0, 2, 1, 3).reshape(B, S, D) @ wo

    def _B_ref(x, wq, wk, wv, wo):
        B, S, D = x.shape
        H = 32
        Dh = D // H
        q = (lambda x, *d: x.permute(*d))((x @ wq).reshape(B, S, H, Dh), 0, 2, 1, 3)
        k = x @ wk
        v = x @ wv
        scores = torch.einsum("bhqd,bkd->bhqk", q, k) * (Dh ** -0.5)
        p = _softmax(scores, axis=-1)
        o = torch.einsum("bhqk,bkd->bhqd", p, v)
        return (lambda x, *d: x.permute(*d))(o, 0, 2, 1, 3).reshape(B, S, H * Dh) @ wo

    x = A_x
    g = _sigmoid((x * gate_w).sum(-1, keepdims=True))
    a = _A_ref(x, A_wqkv, A_wo)
    b = _B_ref(x, B_wq, B_wk, B_wv, B_wo)
    return g * a + (1 - g) * b
```

```asm
; @launch grid=(256,1,1) block=(512,1,1) lds=159744
.amdgcn_target "amdgcn-amd-amdhsa--gfx950"
.text
.globl gated_mix__softmax_full_mha__grouped_kv_mqa__prompt_kernel
.p2align 8
.type gated_mix__softmax_full_mha__grouped_kv_mqa__prompt_kernel,@function
gated_mix__softmax_full_mha__grouped_kv_mqa__prompt_kernel:
    s_cmp_ge_u32 s2, 256
    s_cbranch_scc1 L_exit
    s_load_dwordx4 s[80:83], s[0:1], 0
    s_load_dwordx4 s[84:87], s[0:1], 32
    s_load_dwordx4 s[88:91], s[0:1], 48
    s_load_dwordx4 s[92:95], s[0:1], 64
    s_load_dwordx4 s[96:99], s[0:1], 80
    s_load_dwordx2 s[100:101], s[0:1], 16
    v_and_b32 v1, 63, v0
    v_lshrrev_b32 v2, 6, v0
    s_memrealtime s[52:53]
    v_readfirstlane_b32 s30, v2
    s_and_b32 s20, s2, 7
    s_lshr_b32 s21, s2, 3
    s_and_b32 s22, s20, 3
    s_lshl_b32 s22, s22, 2
    s_and_b32 s23, s21, 3
    s_add_u32 s28, s22, s23
    s_lshr_b32 s22, s20, 2
    s_lshl_b32 s22, s22, 3
    s_lshr_b32 s23, s21, 2
    s_add_u32 s29, s22, s23
    s_lshr_b32 s31, s30, 2
    s_and_b32 s32, s30, 3
    s_lshl_b32 s33, s29, 1
    s_add_u32 s33, s33, s31
    s_lshl_b32 s34, s28, 2
    s_add_u32 s34, s34, s32
    s_and_b32 s44, s28, 3
    s_lshl_b32 s44, s44, 1
    s_add_u32 s44, s44, s29
    s_and_b32 s44, s44, 7
    v_lshrrev_b32 v80, 3, v1
    s_lshl_b32 s40, s28, 7
    s_lshl_b32 s41, s32, 5
    s_add_u32 s40, s40, s41
    s_lshl_b32 s41, s31, 4
    s_add_u32 s40, s40, s41
    v_add_u32 v80, s40, v80
    v_lshlrev_b32 v80, 10, v80
    v_and_b32 v81, 7, v1
    v_lshrrev_b32 v82, 4, v1
    v_xor_b32 v81, v81, v82
    v_lshl_add_u32 v2, v81, 4, v80
    v_xor_b32 v81, 4, v81
    v_lshl_add_u32 v3, v81, 4, v80
    v_add_u32 v3, 8192, v3
    v_lshlrev_b32 v4, 4, v1
    v_lshrrev_b32 v80, 2, v1
    v_and_b32 v81, 3, v1
    s_lshl_b32 s40, s32, 4
    v_add_u32 v80, s40, v80
    s_lshl_b32 s40, s29, 6
    v_lshlrev_b32 v81, 4, v81
    v_add_u32 v81, s40, v81
    v_lshl_add_u32 v6, v80, 10, v81
    v_mul_u32_u24 v7, 3072, v80
    v_add_u32 v7, v7, v81
    v_and_b32 v80, 31, v1
    s_lshl_b32 s40, s32, 5
    v_add_u32 v80, s40, v80
    v_bfe_u32 v81, v80, 1, 3
    v_lshrrev_b32 v82, 5, v1
    v_lshlrev_b32 v80, 7, v80
    v_add_u32 v83, 0, v82
    v_xor_b32 v83, v83, v81
    v_lshl_add_u32 v8, v83, 4, v80
    v_add_u32 v83, 2, v82
    v_xor_b32 v83, v83, v81
    v_lshl_add_u32 v9, v83, 4, v80
    v_add_u32 v83, 4, v82
    v_xor_b32 v83, v83, v81
    v_lshl_add_u32 v10, v83, 4, v80
    v_add_u32 v83, 6, v82
    v_xor_b32 v83, v83, v81
    v_lshl_add_u32 v11, v83, 4, v80
    v_lshrrev_b32 v80, 5, v1
    v_bfe_u32 v81, v1, 4, 1
    v_bfe_u32 v82, v1, 2, 2
    v_and_b32 v83, 3, v1
    v_lshl_add_u32 v84, v80, 3, v82
    v_lshlrev_b32 v13, 5, v84
    v_lshl_add_u32 v13, v83, 3, v13
    v_add_u32 v13, 135168, v13
    v_lshlrev_b32 v15, 4, v80
    v_add_u32 v15, 151552, v15
    v_lshlrev_b32 v12, 6, v84
    v_lshl_add_u32 v12, v81, 5, v12
    v_lshl_add_u32 v12, v83, 3, v12
    s_lshl_b32 s40, s31, 12
    v_add_u32 v12, s40, v12
    v_mul_u32_u24 v14, 4128, v81
    v_lshl_add_u32 v14, v84, 6, v14
    v_lshl_add_u32 v14, v83, 3, v14
    s_lshl_b32 s40, s31, 5
    s_add_u32 s40, s40, 67584
    v_add_u32 v14, s40, v14
    s_waitcnt lgkmcnt(0)
    s_mov_b32 s60, s96
    s_and_b32 s61, s97, 0xffff
    s_mov_b32 s62, 256
    s_mov_b32 s63, 0x00020000
    s_or_b32 s40, s2, s30
    s_cmp_eq_u32 s40, 0
    s_cbranch_scc0 L_noepoch
    s_or_b32 s52, s52, 1
    v_mov_b32 v80, s52
    v_mov_b32 v81, s53
    v_mov_b32 v82, 0
    s_mov_b64 exec, 1
    buffer_store_dwordx2 v[80:81], v82, s[60:63], 0 offen sc1
    s_mov_b64 exec, -1
L_noepoch:
    s_mov_b32 s12, s80
    s_and_b32 s13, s81, 0xffff
    s_mov_b32 s14, 2097152
    s_mov_b32 s15, 0x00020000
    s_mov_b32 s16, s82
    s_and_b32 s17, s83, 0xffff
    s_mov_b32 s18, 1572864
    s_mov_b32 s19, 0x00020000
    s_mov_b32 s20, s84
    s_and_b32 s21, s85, 0xffff
    s_mov_b32 s22, 524288
    s_mov_b32 s23, 0x00020000
    s_cmp_lt_u32 s29, 8
    s_cselect_b32 s24, s86, s88
    s_cselect_b32 s25, s87, s89
    s_and_b32 s25, s25, 0xffff
    s_mov_b32 s26, 16384
    s_mov_b32 s27, 0x00020000
    s_add_u32 s80, s44, 0
    s_and_b32 s80, s80, 7
    s_add_u32 s81, s44, 1
    s_and_b32 s81, s81, 7
    s_add_u32 s82, s44, 2
    s_and_b32 s82, s82, 7
    s_add_u32 s83, s44, 3
    s_and_b32 s83, s83, 7
    s_add_u32 s84, s44, 4
    s_and_b32 s84, s84, 7
    s_add_u32 s85, s44, 5
    s_and_b32 s85, s85, 7
    s_add_u32 s86, s44, 6
    s_and_b32 s86, s86, 7
    s_add_u32 s87, s44, 7
    s_and_b32 s87, s87, 7
    s_lshl_b32 s38, s32, 12
    s_lshl_b32 s40, s31, 11
    s_add_u32 s38, s38, s40
    s_bitcmp0_b32 s29, 2
    s_cselect_b32 s47, 1, 0
    s_cbranch_scc0 L_fs_noduty
    s_add_u32 s41, s30, s44
    s_and_b32 s41, s41, 7
    s_lshl_b32 s41, s41, 11
    s_lshl_b32 s42, s30, 11
    s_add_u32 m0, s42, 135168
    s_add_u32 s40, s41, 0
    buffer_load_dwordx4 v4, s[24:27], s40 offen lds
    s_add_u32 m0, s42, 136192
    s_add_u32 s40, s41, 1024
    buffer_load_dwordx4 v4, s[24:27], s40 offen lds
    s_cmp_eq_u32 s30, 4
    s_cbranch_scc0 L_fs_noduty
    s_mov_b32 s24, s92
    s_and_b32 s25, s93, 0xffff
    s_mov_b32 s26, 1024
    v_lshrrev_b32 v80, 3, v1
    v_add_u32 v80, s44, v80
    v_and_b32 v80, 7, v80
    v_and_b32 v81, 7, v1
    v_lshlrev_b32 v81, 4, v81
    v_lshl_add_u32 v80, v80, 7, v81
    s_mov_b32 m0, 151552
    s_nop 0
    buffer_load_dwordx4 v80, s[24:27], 0 offen lds
L_fs_noduty:
    s_and_b32 s40, s29, 3
    s_cmp_eq_u32 s40, s32
    s_cbranch_scc1 L_fs_lead
    s_barrier
    s_lshl_b32 s40, s80, 7
    s_add_u32 m0, s38, 0
    s_nop 0
    buffer_load_dwordx4 v2, s[12:15], s40 offen lds
    s_add_u32 m0, s38, 1024
    s_nop 0
    buffer_load_dwordx4 v3, s[12:15], s40 offen lds
    s_lshl_b32 s40, s81, 7
    s_add_u32 m0, s38, 16896
    s_nop 0
    buffer_load_dwordx4 v2, s[12:15], s40 offen lds
    s_add_u32 m0, s38, 17920
    s_nop 0
    buffer_load_dwordx4 v3, s[12:15], s40 offen lds
    s_lshl_b32 s40, s82, 7
    s_add_u32 m0, s38, 33792
    s_nop 0
    buffer_load_dwordx4 v2, s[12:15], s40 offen lds
    s_add_u32 m0, s38, 34816
    s_nop 0
    buffer_load_dwordx4 v3, s[12:15], s40 offen lds
    s_lshl_b32 s40, s83, 7
    s_add_u32 m0, s38, 50688
    s_nop 0
    buffer_load_dwordx4 v2, s[12:15], s40 offen lds
    s_add_u32 m0, s38, 51712
    s_nop 0
    buffer_load_dwordx4 v3, s[12:15], s40 offen lds
    s_lshl_b32 s40, s84, 7
    s_add_u32 m0, s38, 67584
    s_nop 0
    buffer_load_dwordx4 v2, s[12:15], s40 offen lds
    s_add_u32 m0, s38, 68608
    s_nop 0
    buffer_load_dwordx4 v3, s[12:15], s40 offen lds
    s_lshl_b32 s40, s85, 7
    s_add_u32 m0, s38, 84480
    s_nop 0
    buffer_load_dwordx4 v2, s[12:15], s40 offen lds
    s_add_u32 m0, s38, 85504
    s_nop 0
    buffer_load_dwordx4 v3, s[12:15], s40 offen lds
    s_lshl_b32 s40, s86, 7
    s_add_u32 m0, s38, 101376
    s_nop 0
    buffer_load_dwordx4 v2, s[12:15], s40 offen lds
    s_add_u32 m0, s38, 102400
    s_nop 0
    buffer_load_dwordx4 v3, s[12:15], s40 offen lds
    s_lshl_b32 s40, s87, 7
    s_add_u32 m0, s38, 118272
    s_nop 0
    buffer_load_dwordx4 v2, s[12:15], s40 offen lds
    s_add_u32 m0, s38, 119296
    s_nop 0
    buffer_load_dwordx4 v3, s[12:15], s40 offen lds
    s_branch L_fs_xdone
L_fs_lead:
    s_lshl_b32 s40, s80, 7
    s_add_u32 m0, s38, 0
    s_nop 0
    buffer_load_dwordx4 v2, s[12:15], s40 offen lds
    s_add_u32 m0, s38, 1024
    s_nop 0
    buffer_load_dwordx4 v3, s[12:15], s40 offen lds
    s_lshl_b32 s40, s81, 7
    s_add_u32 m0, s38, 16896
    s_nop 0
    buffer_load_dwordx4 v2, s[12:15], s40 offen lds
    s_add_u32 m0, s38, 17920
    s_nop 0
    buffer_load_dwordx4 v3, s[12:15], s40 offen lds
    s_lshl_b32 s40, s82, 7
    s_add_u32 m0, s38, 33792
    s_nop 0
    buffer_load_dwordx4 v2, s[12:15], s40 offen lds
    s_add_u32 m0, s38, 34816
    s_nop 0
    buffer_load_dwordx4 v3, s[12:15], s40 offen lds
    s_lshl_b32 s40, s83, 7
    s_add_u32 m0, s38, 50688
    s_nop 0
    buffer_load_dwordx4 v2, s[12:15], s40 offen lds
    s_add_u32 m0, s38, 51712
    s_nop 0
    buffer_load_dwordx4 v3, s[12:15], s40 offen lds
    s_lshl_b32 s40, s84, 7
    s_add_u32 m0, s38, 67584
    s_nop 0
    buffer_load_dwordx4 v2, s[12:15], s40 offen lds
    s_add_u32 m0, s38, 68608
    s_nop 0
    buffer_load_dwordx4 v3, s[12:15], s40 offen lds
    s_lshl_b32 s40, s85, 7
    s_add_u32 m0, s38, 84480
    s_nop 0
    buffer_load_dwordx4 v2, s[12:15], s40 offen lds
    s_add_u32 m0, s38, 85504
    s_nop 0
    buffer_load_dwordx4 v3, s[12:15], s40 offen lds
    s_lshl_b32 s40, s86, 7
    s_add_u32 m0, s38, 101376
    s_nop 0
    buffer_load_dwordx4 v2, s[12:15], s40 offen lds
    s_add_u32 m0, s38, 102400
    s_nop 0
    buffer_load_dwordx4 v3, s[12:15], s40 offen lds
    s_lshl_b32 s40, s87, 7
    s_add_u32 m0, s38, 118272
    s_nop 0
    buffer_load_dwordx4 v2, s[12:15], s40 offen lds
    s_add_u32 m0, s38, 119296
    s_nop 0
    buffer_load_dwordx4 v3, s[12:15], s40 offen lds
    s_barrier
L_fs_xdone:
    s_mov_b32 s8, s98
    s_and_b32 s9, s99, 0xffff
    s_mov_b32 s10, 16777216
    s_mov_b32 s11, 0x00020000
    s_mov_b32 s46, 0
    s_cmp_eq_u32 s31, 1
    s_cbranch_scc1 L_f_V
    s_cmp_eq_u32 s47, 0
    s_cbranch_scc1 L_f_K
    s_and_b32 s40, s29, 3
    s_cmp_eq_u32 s40, s32
    s_cbranch_scc0 L_f_K
    s_cmp_lt_u32 s29, 8
    s_cbranch_scc1 L_f_DK
    s_branch L_f_DV
L_f_DK:
    v_mov_b32 v80, 0
    buffer_load_dwordx2 v[6:7], v80, s[60:63], 0 offen sc1
    s_waitcnt vmcnt(0)
    s_barrier
    s_waitcnt vmcnt(0)
    s_mov_b32 s59, 131072
L_ep_1:
    v_readfirstlane_b32 s52, v6
    v_readfirstlane_b32 s53, v7
    s_nop 3
    s_cmp_lg_u32 s52, 0
    s_cbranch_scc1 L_ep_1_ok
    s_sub_u32 s59, s59, 1
    s_cmp_eq_u32 s59, 0
    s_cbranch_scc1 L_ep_1_ok
    v_mov_b32 v80, 0
    s_sleep 1
    buffer_load_dwordx2 v[6:7], v80, s[60:63], 0 offen sc1
    s_waitcnt vmcnt(0)
    s_branch L_ep_1
L_ep_1_ok:
    ds_read_b128 a[0:3], v8 offset:0
    ds_read_b128 a[4:7], v9 offset:0
    ds_read_b128 a[8:11], v10 offset:0
    ds_read_b128 a[12:15], v11 offset:0
    ds_read_b64_tr_b16 v[32:33], v13 offset:0
    ds_read_b64_tr_b16 v[34:35], v13 offset:128
    ds_read_b64_tr_b16 v[36:37], v13 offset:512
    ds_read_b64_tr_b16 v[38:39], v13 offset:640
    ds_read_b64_tr_b16 v[40:41], v13 offset:1024
    ds_read_b64_tr_b16 v[42:43], v13 offset:1152
    ds_read_b64_tr_b16 v[44:45], v13 offset:1536
    ds_read_b64_tr_b16 v[46:47], v13 offset:1664
    s_mov_b32 exec_lo, 0xffff0000
    s_mov_b32 exec_hi, 0xffff0000
    ds_read_b128 v[32:35], v15 offset:0
    ds_read_b128 v[36:39], v15 offset:32
    ds_read_b128 v[40:43], v15 offset:64
    ds_read_b128 v[44:47], v15 offset:96
    s_mov_b64 exec, -1
    s_waitcnt lgkmcnt(0)
    ds_read_b128 a[16:19], v8 offset:16896
    ds_read_b128 a[20:23], v9 offset:16896
    ds_read_b128 a[24:27], v10 offset:16896
    ds_read_b128 a[28:31], v11 offset:16896
    ds_read_b64_tr_b16 v[16:17], v13 offset:2048
    ds_read_b64_tr_b16 v[18:19], v13 offset:2176
    ds_read_b64_tr_b16 v[20:21], v13 offset:2560
    ds_read_b64_tr_b16 v[22:23], v13 offset:2688
    ds_read_b64_tr_b16 v[24:25], v13 offset:3072
    ds_read_b64_tr_b16 v[26:27], v13 offset:3200
    ds_read_b64_tr_b16 v[28:29], v13 offset:3584
    ds_read_b64_tr_b16 v[30:31], v13 offset:3712
    s_mov_b32 exec_lo, 0xffff0000
    s_mov_b32 exec_hi, 0xffff0000
    ds_read_b128 v[16:19], v15 offset:128
    ds_read_b128 v[20:23], v15 offset:160
    ds_read_b128 v[24:27], v15 offset:192
    ds_read_b128 v[28:31], v15 offset:224
    s_mov_b64 exec, -1
    v_mfma_f32_32x32x16_bf16 v[64:79], v[32:35], a[0:3], 0
    v_mfma_f32_32x32x16_bf16 v[64:79], v[36:39], a[4:7], v[64:79]
    v_mfma_f32_32x32x16_bf16 v[64:79], v[40:43], a[8:11], v[64:79]
    v_mfma_f32_32x32x16_bf16 v[64:79], v[44:47], a[12:15], v[64:79]
    s_waitcnt lgkmcnt(0)
    ds_read_b128 a[32:35], v8 offset:33792
    ds_read_b128 a[36:39], v9 offset:33792
    ds_read_b128 a[40:43], v10 offset:33792
    ds_read_b128 a[44:47], v11 offset:33792
    ds_read_b64_tr_b16 v[32:33], v13 offset:4096
    ds_read_b64_tr_b16 v[34:35], v13 offset:4224
    ds_read_b64_tr_b16 v[36:37], v13 offset:4608
    ds_read_b64_tr_b16 v[38:39], v13 offset:4736
    ds_read_b64_tr_b16 v[40:41], v13 offset:5120
    ds_read_b64_tr_b16 v[42:43], v13 offset:5248
    ds_read_b64_tr_b16 v[44:45], v13 offset:5632
    ds_read_b64_tr_b16 v[46:47], v13 offset:5760
    s_mov_b32 exec_lo, 0xffff0000
    s_mov_b32 exec_hi, 0xffff0000
    ds_read_b128 v[32:35], v15 offset:256
    ds_read_b128 v[36:39], v15 offset:288
    ds_read_b128 v[40:43], v15 offset:320
    ds_read_b128 v[44:47], v15 offset:352
    s_mov_b64 exec, -1
    v_mfma_f32_32x32x16_bf16 v[64:79], v[16:19], a[16:19], v[64:79]
    v_mfma_f32_32x32x16_bf16 v[64:79], v[20:23], a[20:23], v[64:79]
    v_mfma_f32_32x32x16_bf16 v[64:79], v[24:27], a[24:27], v[64:79]
    v_mfma_f32_32x32x16_bf16 v[64:79], v[28:31], a[28:31], v[64:79]
    s_waitcnt lgkmcnt(0)
    ds_read_b128 a[48:51], v8 offset:50688
    ds_read_b128 a[52:55], v9 offset:50688
    ds_read_b128 a[56:59], v10 offset:50688
    ds_read_b128 a[60:63], v11 offset:50688
    ds_read_b64_tr_b16 v[16:17], v13 offset:6144
    ds_read_b64_tr_b16 v[18:19], v13 offset:6272
    ds_read_b64_tr_b16 v[20:21], v13 offset:6656
    ds_read_b64_tr_b16 v[22:23], v13 offset:6784
    ds_read_b64_tr_b16 v[24:25], v13 offset:7168
    ds_read_b64_tr_b16 v[26:27], v13 offset:7296
    ds_read_b64_tr_b16 v[28:29], v13 offset:7680
    ds_read_b64_tr_b16 v[30:31], v13 offset:7808
    s_mov_b32 exec_lo, 0xffff0000
    s_mov_b32 exec_hi, 0xffff0000
    ds_read_b128 v[16:19], v15 offset:384
    ds_read_b128 v[20:23], v15 offset:416
    ds_read_b128 v[24:27], v15 offset:448
    ds_read_b128 v[28:31], v15 offset:480
    s_mov_b64 exec, -1
    v_add_u32 v8, 67584, v8
    v_add_u32 v9, 67584, v9
    v_add_u32 v10, 67584, v10
    v_add_u32 v11, 67584, v11
    v_mfma_f32_32x32x16_bf16 v[64:79], v[32:35], a[32:35], v[64:79]
    v_mfma_f32_32x32x16_bf16 v[64:79], v[36:39], a[36:39], v[64:79]
    v_mfma_f32_32x32x16_bf16 v[64:79], v[40:43], a[40:43], v[64:79]
    v_mfma_f32_32x32x16_bf16 v[64:79], v[44:47], a[44:47], v[64:79]
    s_barrier
    s_waitcnt lgkmcnt(0)
    ds_read_b128 a[64:67], v8 offset:0
    ds_read_b128 a[68:71], v9 offset:0
    ds_read_b128 a[72:75], v10 offset:0
    ds_read_b128 a[76:79], v11 offset:0
    ds_read_b64_tr_b16 v[32:33], v13 offset:8192
    ds_read_b64_tr_b16 v[34:35], v13 offset:8320
    ds_read_b64_tr_b16 v[36:37], v13 offset:8704
    ds_read_b64_tr_b16 v[38:39], v13 offset:8832
    ds_read_b64_tr_b16 v[40:41], v13 offset:9216
    ds_read_b64_tr_b16 v[42:43], v13 offset:9344
    ds_read_b64_tr_b16 v[44:45], v13 offset:9728
    ds_read_b64_tr_b16 v[46:47], v13 offset:9856
    s_mov_b32 exec_lo, 0xffff0000
    s_mov_b32 exec_hi, 0xffff0000
    ds_read_b128 v[32:35], v15 offset:512
    ds_read_b128 v[36:39], v15 offset:544
    ds_read_b128 v[40:43], v15 offset:576
    ds_read_b128 v[44:47], v15 offset:608
    s_mov_b64 exec, -1
    v_mfma_f32_32x32x16_bf16 v[64:79], v[16:19], a[48:51], v[64:79]
    v_mfma_f32_32x32x16_bf16 v[64:79], v[20:23], a[52:55], v[64:79]
    v_mfma_f32_32x32x16_bf16 v[64:79], v[24:27], a[56:59], v[64:79]
    v_mfma_f32_32x32x16_bf16 v[64:79], v[28:31], a[60:63], v[64:79]
    s_barrier
    s_waitcnt lgkmcnt(0)
    ds_read_b128 a[80:83], v8 offset:16896
    ds_read_b128 a[84:87], v9 offset:16896
    ds_read_b128 a[88:91], v10 offset:16896
    ds_read_b128 a[92:95], v11 offset:16896
    ds_read_b64_tr_b16 v[16:17], v13 offset:10240
    ds_read_b64_tr_b16 v[18:19], v13 offset:10368
    ds_read_b64_tr_b16 v[20:21], v13 offset:10752
    ds_read_b64_tr_b16 v[22:23], v13 offset:10880
    ds_read_b64_tr_b16 v[24:25], v13 offset:11264
    ds_read_b64_tr_b16 v[26:27], v13 offset:11392
    ds_read_b64_tr_b16 v[28:29], v13 offset:11776
    ds_read_b64_tr_b16 v[30:31], v13 offset:11904
    s_mov_b32 exec_lo, 0xffff0000
    s_mov_b32 exec_hi, 0xffff0000
    ds_read_b128 v[16:19], v15 offset:640
    ds_read_b128 v[20:23], v15 offset:672
    ds_read_b128 v[24:27], v15 offset:704
    ds_read_b128 v[28:31], v15 offset:736
    s_mov_b64 exec, -1
    v_mfma_f32_32x32x16_bf16 v[64:79], v[32:35], a[64:67], v[64:79]
    v_mfma_f32_32x32x16_bf16 v[64:79], v[36:39], a[68:71], v[64:79]
    v_mfma_f32_32x32x16_bf16 v[64:79], v[40:43], a[72:75], v[64:79]
    v_mfma_f32_32x32x16_bf16 v[64:79], v[44:47], a[76:79], v[64:79]
    s_barrier
    s_waitcnt lgkmcnt(0)
    ds_read_b128 a[96:99], v8 offset:33792
    ds_read_b128 a[100:103], v9 offset:33792
    ds_read_b128 a[104:107], v10 offset:33792
    ds_read_b128 a[108:111], v11 offset:33792
    ds_read_b64_tr_b16 v[32:33], v13 offset:12288
    ds_read_b64_tr_b16 v[34:35], v13 offset:12416
    ds_read_b64_tr_b16 v[36:37], v13 offset:12800
    ds_read_b64_tr_b16 v[38:39], v13 offset:12928
    ds_read_b64_tr_b16 v[40:41], v13 offset:13312
    ds_read_b64_tr_b16 v[42:43], v13 offset:13440
    ds_read_b64_tr_b16 v[44:45], v13 offset:13824
    ds_read_b64_tr_b16 v[46:47], v13 offset:13952
    s_mov_b32 exec_lo, 0xffff0000
    s_mov_b32 exec_hi, 0xffff0000
    ds_read_b128 v[32:35], v15 offset:768
    ds_read_b128 v[36:39], v15 offset:800
    ds_read_b128 v[40:43], v15 offset:832
    ds_read_b128 v[44:47], v15 offset:864
    s_mov_b64 exec, -1
    v_mfma_f32_32x32x16_bf16 v[64:79], v[16:19], a[80:83], v[64:79]
    v_mfma_f32_32x32x16_bf16 v[64:79], v[20:23], a[84:87], v[64:79]
    v_mfma_f32_32x32x16_bf16 v[64:79], v[24:27], a[88:91], v[64:79]
    v_mfma_f32_32x32x16_bf16 v[64:79], v[28:31], a[92:95], v[64:79]
    s_barrier
    s_waitcnt lgkmcnt(0)
    ds_read_b128 a[112:115], v8 offset:50688
    ds_read_b128 a[116:119], v9 offset:50688
    ds_read_b128 a[120:123], v10 offset:50688
    ds_read_b128 a[124:127], v11 offset:50688
    ds_read_b64_tr_b16 v[16:17], v13 offset:14336
    ds_read_b64_tr_b16 v[18:19], v13 offset:14464
    ds_read_b64_tr_b16 v[20:21], v13 offset:14848
    ds_read_b64_tr_b16 v[22:23], v13 offset:14976
    ds_read_b64_tr_b16 v[24:25], v13 offset:15360
    ds_read_b64_tr_b16 v[26:27], v13 offset:15488
    ds_read_b64_tr_b16 v[28:29], v13 offset:15872
    ds_read_b64_tr_b16 v[30:31], v13 offset:16000
    s_mov_b32 exec_lo, 0xffff0000
    s_mov_b32 exec_hi, 0xffff0000
    ds_read_b128 v[16:19], v15 offset:896
    ds_read_b128 v[20:23], v15 offset:928
    ds_read_b128 v[24:27], v15 offset:960
    ds_read_b128 v[28:31], v15 offset:992
    s_mov_b64 exec, -1
    v_mfma_f32_32x32x16_bf16 v[64:79], v[32:35], a[96:99], v[64:79]
    v_mfma_f32_32x32x16_bf16 v[64:79], v[36:39], a[100:103], v[64:79]
    v_mfma_f32_32x32x16_bf16 v[64:79], v[40:43], a[104:107], v[64:79]
    v_mfma_f32_32x32x16_bf16 v[64:79], v[44:47], a[108:111], v[64:79]
    s_barrier
    s_waitcnt lgkmcnt(0)
    v_mfma_f32_32x32x16_bf16 v[64:79], v[16:19], a[112:115], v[64:79]
    v_mfma_f32_32x32x16_bf16 v[64:79], v[20:23], a[116:119], v[64:79]
    v_mfma_f32_32x32x16_bf16 v[64:79], v[24:27], a[120:123], v[64:79]
    v_mfma_f32_32x32x16_bf16 v[64:79], v[28:31], a[124:127], v[64:79]
    s_nop 7
    s_nop 7
    s_lshl_b32 s40, s34, 11
    s_add_u32 s40, s40, 8388608
    v_cvt_pk_bf16_f32 v32, v64, v65
    v_cvt_pk_bf16_f32 v33, v66, v67
    v_cvt_pk_bf16_f32 v34, v68, v69
    v_cvt_pk_bf16_f32 v35, v70, v71
    v_lshlrev_b32 v80, 4, v1
    buffer_store_dwordx4 v[32:35], v80, s[8:11], s40 offen sc1
    v_mul_f32 v82, 0xbfb8aa3b, v72
    s_nop 0
    v_exp_f32 v82, v82
    s_nop 0
    v_add_f32 v82, 1.0, v82
    s_nop 0
    v_rcp_f32 v82, v82
    v_and_b32 v81, 31, v1
    v_lshlrev_b32 v81, 2, v81
    s_lshl_b32 s41, s34, 7
    s_add_u32 s41, s41, 8519680
    s_mov_b32 exec_hi, 0
    buffer_store_dword v82, v81, s[8:11], s41 offen sc1
    s_mov_b64 exec, -1
    s_lshl_b32 s46, s34, 3
    s_add_u32 s46, s46, 15728640
    s_barrier
    s_barrier
    s_barrier
    s_waitcnt lgkmcnt(0)
    s_barrier
    s_branch L_f_K1b
L_f_DV:
    v_mov_b32 v80, 0
    buffer_load_dwordx2 v[6:7], v80, s[60:63], 0 offen sc1
    s_waitcnt vmcnt(0)
    s_barrier
    s_waitcnt vmcnt(0)
    s_mov_b32 s59, 131072
L_ep_2:
    v_readfirstlane_b32 s52, v6
    v_readfirstlane_b32 s53, v7
    s_nop 3
    s_cmp_lg_u32 s52, 0
    s_cbranch_scc1 L_ep_2_ok
    s_sub_u32 s59, s59, 1
    s_cmp_eq_u32 s59, 0
    s_cbranch_scc1 L_ep_2_ok
    v_mov_b32 v80, 0
    s_sleep 1
    buffer_load_dwordx2 v[6:7], v80, s[60:63], 0 offen sc1
    s_waitcnt vmcnt(0)
    s_branch L_ep_2
L_ep_2_ok:
    ds_read_b128 a[0:3], v8 offset:0
    ds_read_b128 a[4:7], v9 offset:0
    ds_read_b128 a[8:11], v10 offset:0
    ds_read_b128 a[12:15], v11 offset:0
    ds_read_b64_tr_b16 v[32:33], v13 offset:0
    ds_read_b64_tr_b16 v[34:35], v13 offset:128
    ds_read_b64_tr_b16 v[36:37], v13 offset:512
    ds_read_b64_tr_b16 v[38:39], v13 offset:640
    ds_read_b64_tr_b16 v[40:41], v13 offset:1024
    ds_read_b64_tr_b16 v[42:43], v13 offset:1152
    ds_read_b64_tr_b16 v[44:45], v13 offset:1536
    ds_read_b64_tr_b16 v[46:47], v13 offset:1664
    s_waitcnt lgkmcnt(0)
    ds_read_b128 a[16:19], v8 offset:16896
    ds_read_b128 a[20:23], v9 offset:16896
    ds_read_b128 a[24:27], v10 offset:16896
    ds_read_b128 a[28:31], v11 offset:16896
    ds_read_b64_tr_b16 v[16:17], v13 offset:2048
    ds_read_b64_tr_b16 v[18:19], v13 offset:2176
    ds_read_b64_tr_b16 v[20:21], v13 offset:2560
    ds_read_b64_tr_b16 v[22:23], v13 offset:2688
    ds_read_b64_tr_b16 v[24:25], v13 offset:3072
    ds_read_b64_tr_b16 v[26:27], v13 offset:3200
    ds_read_b64_tr_b16 v[28:29], v13 offset:3584
    ds_read_b64_tr_b16 v[30:31], v13 offset:3712
    v_mfma_f32_32x32x16_bf16 v[64:79], a[0:3], v[32:35], 0
    v_mfma_f32_32x32x16_bf16 v[64:79], a[4:7], v[36:39], v[64:79]
    v_mfma_f32_32x32x16_bf16 v[64:79], a[8:11], v[40:43], v[64:79]
    v_mfma_f32_32x32x16_bf16 v[64:79], a[12:15], v[44:47], v[64:79]
    s_waitcnt lgkmcnt(0)
    ds_read_b128 a[32:35], v8 offset:33792
    ds_read_b128 a[36:39], v9 offset:33792
    ds_read_b128 a[40:43], v10 offset:33792
    ds_read_b128 a[44:47], v11 offset:33792
    ds_read_b64_tr_b16 v[32:33], v13 offset:4096
    ds_read_b64_tr_b16 v[34:35], v13 offset:4224
    ds_read_b64_tr_b16 v[36:37], v13 offset:4608
    ds_read_b64_tr_b16 v[38:39], v13 offset:4736
    ds_read_b64_tr_b16 v[40:41], v13 offset:5120
    ds_read_b64_tr_b16 v[42:43], v13 offset:5248
    ds_read_b64_tr_b16 v[44:45], v13 offset:5632
    ds_read_b64_tr_b16 v[46:47], v13 offset:5760
    v_mfma_f32_32x32x16_bf16 v[64:79], a[16:19], v[16:19], v[64:79]
    v_mfma_f32_32x32x16_bf16 v[64:79], a[20:23], v[20:23], v[64:79]
    v_mfma_f32_32x32x16_bf16 v[64:79], a[24:27], v[24:27], v[64:79]
    v_mfma_f32_32x32x16_bf16 v[64:79], a[28:31], v[28:31], v[64:79]
    s_waitcnt lgkmcnt(0)
    ds_read_b128 a[48:51], v8 offset:50688
    ds_read_b128 a[52:55], v9 offset:50688
    ds_read_b128 a[56:59], v10 offset:50688
    ds_read_b128 a[60:63], v11 offset:50688
    ds_read_b64_tr_b16 v[16:17], v13 offset:6144
    ds_read_b64_tr_b16 v[18:19], v13 offset:6272
    ds_read_b64_tr_b16 v[20:21], v13 offset:6656
    ds_read_b64_tr_b16 v[22:23], v13 offset:6784
    ds_read_b64_tr_b16 v[24:25], v13 offset:7168
    ds_read_b64_tr_b16 v[26:27], v13 offset:7296
    ds_read_b64_tr_b16 v[28:29], v13 offset:7680
    ds_read_b64_tr_b16 v[30:31], v13 offset:7808
    v_add_u32 v8, 67584, v8
    v_add_u32 v9, 67584, v9
    v_add_u32 v10, 67584, v10
    v_add_u32 v11, 67584, v11
    v_mfma_f32_32x32x16_bf16 v[64:79], a[32:35], v[32:35], v[64:79]
    v_mfma_f32_32x32x16_bf16 v[64:79], a[36:39], v[36:39], v[64:79]
    v_mfma_f32_32x32x16_bf16 v[64:79], a[40:43], v[40:43], v[64:79]
    v_mfma_f32_32x32x16_bf16 v[64:79], a[44:47], v[44:47], v[64:79]
    s_barrier
    s_waitcnt lgkmcnt(0)
    ds_read_b128 a[64:67], v8 offset:0
    ds_read_b128 a[68:71], v9 offset:0
    ds_read_b128 a[72:75], v10 offset:0
    ds_read_b128 a[76:79], v11 offset:0
    ds_read_b64_tr_b16 v[32:33], v13 offset:8192
    ds_read_b64_tr_b16 v[34:35], v13 offset:8320
    ds_read_b64_tr_b16 v[36:37], v13 offset:8704
    ds_read_b64_tr_b16 v[38:39], v13 offset:8832
    ds_read_b64_tr_b16 v[40:41], v13 offset:9216
    ds_read_b64_tr_b16 v[42:43], v13 offset:9344
    ds_read_b64_tr_b16 v[44:45], v13 offset:9728
    ds_read_b64_tr_b16 v[46:47], v13 offset:9856
    v_mfma_f32_32x32x16_bf16 v[64:79], a[48:51], v[16:19], v[64:79]
    v_mfma_f32_32x32x16_bf16 v[64:79], a[52:55], v[20:23], v[64:79]
    v_mfma_f32_32x32x16_bf16 v[64:79], a[56:59], v[24:27], v[64:79]
    v_mfma_f32_32x32x16_bf16 v[64:79], a[60:63], v[28:31], v[64:79]
    s_barrier
    s_waitcnt lgkmcnt(0)
    ds_read_b128 a[80:83], v8 offset:16896
    ds_read_b128 a[84:87], v9 offset:16896
    ds_read_b128 a[88:91], v10 offset:16896
    ds_read_b128 a[92:95], v11 offset:16896
    ds_read_b64_tr_b16 v[16:17], v13 offset:10240
    ds_read_b64_tr_b16 v[18:19], v13 offset:10368
    ds_read_b64_tr_b16 v[20:21], v13 offset:10752
    ds_read_b64_tr_b16 v[22:23], v13 offset:10880
    ds_read_b64_tr_b16 v[24:25], v13 offset:11264
    ds_read_b64_tr_b16 v[26:27], v13 offset:11392
    ds_read_b64_tr_b16 v[28:29], v13 offset:11776
    ds_read_b64_tr_b16 v[30:31], v13 offset:11904
    v_mfma_f32_32x32x16_bf16 v[64:79], a[64:67], v[32:35], v[64:79]
    v_mfma_f32_32x32x16_bf16 v[64:79], a[68:71], v[36:39], v[64:79]
    v_mfma_f32_32x32x16_bf16 v[64:79], a[72:75], v[40:43], v[64:79]
    v_mfma_f32_32x32x16_bf16 v[64:79], a[76:79], v[44:47], v[64:79]
    s_barrier
    s_waitcnt lgkmcnt(0)
    ds_read_b128 a[96:99], v8 offset:33792
    ds_read_b128 a[100:103], v9 offset:33792
    ds_read_b128 a[104:107], v10 offset:33792
    ds_read_b128 a[108:111], v11 offset:33792
    ds_read_b64_tr_b16 v[32:33], v13 offset:12288
    ds_read_b64_tr_b16 v[34:35], v13 offset:12416
    ds_read_b64_tr_b16 v[36:37], v13 offset:12800
    ds_read_b64_tr_b16 v[38:39], v13 offset:12928
    ds_read_b64_tr_b16 v[40:41], v13 offset:13312
    ds_read_b64_tr_b16 v[42:43], v13 offset:13440
    ds_read_b64_tr_b16 v[44:45], v13 offset:13824
    ds_read_b64_tr_b16 v[46:47], v13 offset:13952
    v_mfma_f32_32x32x16_bf16 v[64:79], a[80:83], v[16:19], v[64:79]
    v_mfma_f32_32x32x16_bf16 v[64:79], a[84:87], v[20:23], v[64:79]
    v_mfma_f32_32x32x16_bf16 v[64:79], a[88:91], v[24:27], v[64:79]
    v_mfma_f32_32x32x16_bf16 v[64:79], a[92:95], v[28:31], v[64:79]
    s_barrier
    s_waitcnt lgkmcnt(0)
    ds_read_b128 a[112:115], v8 offset:50688
    ds_read_b128 a[116:119], v9 offset:50688
    ds_read_b128 a[120:123], v10 offset:50688
    ds_read_b128 a[124:127], v11 offset:50688
    ds_read_b64_tr_b16 v[16:17], v13 offset:14336
    ds_read_b64_tr_b16 v[18:19], v13 offset:14464
    ds_read_b64_tr_b16 v[20:21], v13 offset:14848
    ds_read_b64_tr_b16 v[22:23], v13 offset:14976
    ds_read_b64_tr_b16 v[24:25], v13 offset:15360
    ds_read_b64_tr_b16 v[26:27], v13 offset:15488
    ds_read_b64_tr_b16 v[28:29], v13 offset:15872
    ds_read_b64_tr_b16 v[30:31], v13 offset:16000
    v_mfma_f32_32x32x16_bf16 v[64:79], a[96:99], v[32:35], v[64:79]
    v_mfma_f32_32x32x16_bf16 v[64:79], a[100:103], v[36:39], v[64:79]
    v_mfma_f32_32x32x16_bf16 v[64:79], a[104:107], v[40:43], v[64:79]
    v_mfma_f32_32x32x16_bf16 v[64:79], a[108:111], v[44:47], v[64:79]
    s_barrier
    s_waitcnt lgkmcnt(0)
    v_mfma_f32_32x32x16_bf16 v[64:79], a[112:115], v[16:19], v[64:79]
    v_mfma_f32_32x32x16_bf16 v[64:79], a[116:119], v[20:23], v[64:79]
    v_mfma_f32_32x32x16_bf16 v[64:79], a[120:123], v[24:27], v[64:79]
    v_mfma_f32_32x32x16_bf16 v[64:79], a[124:127], v[28:31], v[64:79]
    s_nop 7
    s_nop 7
    s_lshl_b32 s40, s34, 11
    s_add_u32 s40, s40, 8388608
    v_cvt_pk_bf16_f32 v32, v64, v65
    v_cvt_pk_bf16_f32 v33, v66, v67
    v_cvt_pk_bf16_f32 v34, v68, v69
    v_cvt_pk_bf16_f32 v35, v70, v71
    v_cvt_pk_bf16_f32 v36, v72, v73
    v_cvt_pk_bf16_f32 v37, v74, v75
    v_cvt_pk_bf16_f32 v38, v76, v77
    v_cvt_pk_bf16_f32 v39, v78, v79
    v_lshrrev_b32 v81, 5, v1
    v_lshlrev_b32 v80, 8, v81
    v_and_b32 v81, 15, v1
    v_lshl_add_u32 v80, v81, 4, v80
    s_mov_b32 exec_lo, 0xffff
    s_mov_b32 exec_hi, 0xffff
    buffer_store_dwordx4 v[32:35], v80, s[8:11], s40 offen offset:1024 sc1
    buffer_store_dwordx4 v[36:39], v80, s[8:11], s40 offen offset:1536 sc1
    s_mov_b64 exec, -1
    s_lshl_b32 s46, s34, 3
    s_add_u32 s46, s46, 15729152
    s_barrier
    s_barrier
    s_barrier
    s_waitcnt lgkmcnt(0)
    s_barrier
    s_branch L_f_K1b
L_f_K:
    v_mov_b32 v80, 0
    buffer_load_dwordx2 v[6:7], v80, s[60:63], 0 offen sc1
    s_cmp_eq_u32 s47, 0
    s_cbranch_scc1 L_nod_3
    s_and_b32 s40, s29, 3
    s_cmp_eq_u32 s40, s32
    s_cbranch_scc1 L_nod_3_lead
    s_waitcnt vmcnt(17)
    s_barrier
    s_branch L_nod_3
L_nod_3_lead:
    s_waitcnt vmcnt(0)
    s_barrier
L_nod_3:
    s_waitcnt vmcnt(15) lgkmcnt(0)
    s_barrier
    ds_read_b128 a[0:3], v8 offset:0
    ds_read_b128 a[4:7], v9 offset:0
    ds_read_b128 a[8:11], v10 offset:0
    ds_read_b128 a[12:15], v11 offset:0
    s_waitcnt vmcnt(13) lgkmcnt(4)
    s_barrier
    ds_read_b128 a[16:19], v8 offset:16896
    ds_read_b128 a[20:23], v9 offset:16896
    ds_read_b128 a[24:27], v10 offset:16896
    ds_read_b128 a[28:31], v11 offset:16896
    s_waitcnt vmcnt(11) lgkmcnt(4)
    s_barrier
    ds_read_b128 a[32:35], v8 offset:33792
    ds_read_b128 a[36:39], v9 offset:33792
    ds_read_b128 a[40:43], v10 offset:33792
    ds_read_b128 a[44:47], v11 offset:33792
    s_waitcnt vmcnt(9) lgkmcnt(4)
    s_barrier
    ds_read_b128 a[48:51], v8 offset:50688
    ds_read_b128 a[52:55], v9 offset:50688
    ds_read_b128 a[56:59], v10 offset:50688
    ds_read_b128 a[60:63], v11 offset:50688
    v_add_u32 v8, 67584, v8
    v_add_u32 v9, 67584, v9
    v_add_u32 v10, 67584, v10
    v_add_u32 v11, 67584, v11
    s_waitcnt vmcnt(7) lgkmcnt(4)
    s_barrier
    ds_read_b128 a[64:67], v8 offset:0
    ds_read_b128 a[68:71], v9 offset:0
    ds_read_b128 a[72:75], v10 offset:0
    ds_read_b128 a[76:79], v11 offset:0
    s_waitcnt vmcnt(5) lgkmcnt(4)
    s_barrier
    ds_read_b128 a[80:83], v8 offset:16896
    ds_read_b128 a[84:87], v9 offset:16896
    ds_read_b128 a[88:91], v10 offset:16896
    ds_read_b128 a[92:95], v11 offset:16896
    s_waitcnt vmcnt(3) lgkmcnt(4)
    s_barrier
    ds_read_b128 a[96:99], v8 offset:33792
    ds_read_b128 a[100:103], v9 offset:33792
    ds_read_b128 a[104:107], v10 offset:33792
    ds_read_b128 a[108:111], v11 offset:33792
    s_waitcnt vmcnt(1) lgkmcnt(4)
    s_barrier
    ds_read_b128 a[112:115], v8 offset:50688
    ds_read_b128 a[116:119], v9 offset:50688
    ds_read_b128 a[120:123], v10 offset:50688
    ds_read_b128 a[124:127], v11 offset:50688
    s_waitcnt lgkmcnt(0)
    s_barrier
    s_waitcnt vmcnt(0)
    s_mov_b32 s59, 131072
L_ep_4:
    v_readfirstlane_b32 s52, v6
    v_readfirstlane_b32 s53, v7
    s_nop 3
    s_cmp_lg_u32 s52, 0
    s_cbranch_scc1 L_ep_4_ok
    s_sub_u32 s59, s59, 1
    s_cmp_eq_u32 s59, 0
    s_cbranch_scc1 L_ep_4_ok
    v_mov_b32 v80, 0
    s_sleep 1
    buffer_load_dwordx2 v[6:7], v80, s[60:63], 0 offen sc1
    s_waitcnt vmcnt(0)
    s_branch L_ep_4
L_ep_4_ok:
L_f_K1b:
    s_barrier
    ds_read_b64_tr_b16 v[16:17], v12 offset:0
    ds_read_b64_tr_b16 v[18:19], v12 offset:256
    ds_read_b64_tr_b16 v[20:21], v12 offset:1024
    ds_read_b64_tr_b16 v[22:23], v12 offset:1280
    ds_read_b64_tr_b16 v[24:25], v12 offset:2048
    ds_read_b64_tr_b16 v[26:27], v12 offset:2304
    ds_read_b64_tr_b16 v[28:29], v12 offset:3072
    ds_read_b64_tr_b16 v[30:31], v12 offset:3328
    s_waitcnt lgkmcnt(6)
    v_mfma_f32_32x32x16_bf16 v[48:63], v[16:19], a[0:3], 0
    ds_read_b64_tr_b16 v[16:17], v12 offset:8256
    ds_read_b64_tr_b16 v[18:19], v12 offset:8512
    s_waitcnt lgkmcnt(6)
    v_mfma_f32_32x32x16_bf16 v[48:63], v[20:23], a[4:7], v[48:63]
    v_and_b32 v106, 31, v0
    v_cmp_eq_u32 vcc, 0, v106
    v_mov_b32 v111, 0x3f803f80
    s_nop 0
    ds_read_b64_tr_b16 v[20:21], v12 offset:9280
    ds_read_b64_tr_b16 v[22:23], v12 offset:9536
    s_waitcnt lgkmcnt(6)
    v_mfma_f32_32x32x16_bf16 v[48:63], v[24:27], a[8:11], v[48:63]
    v_cndmask_b32 v106, 0, v111, vcc
    v_mov_b32 v107, v106
    v_mov_b32 v108, v106
    v_mov_b32 v109, v106
    ds_read_b64_tr_b16 v[24:25], v12 offset:10304
    ds_read_b64_tr_b16 v[26:27], v12 offset:10560
    s_waitcnt lgkmcnt(6)
    v_mfma_f32_32x32x16_bf16 v[48:63], v[28:31], a[12:15], v[48:63]
    v_min_u32 v110, 447, v0
    v_cmp_gt_u32 vcc, 448, v0
    v_lshlrev_b32 v110, 4, v110
    v_add_u32 v110, 152576, v110
    ds_read_b64_tr_b16 v[28:29], v12 offset:11328
    ds_read_b64_tr_b16 v[30:31], v12 offset:11584
    s_waitcnt lgkmcnt(6)
    v_mfma_f32_32x32x16_bf16 v[48:63], v[16:19], a[16:19], v[48:63]
    v_cndmask_b32 v106, 0, v106, vcc
    v_cndmask_b32 v107, 0, v107, vcc
    v_cndmask_b32 v108, 0, v108, vcc
    v_cndmask_b32 v109, 0, v109, vcc
    s_cmp_eq_u32 s46, 0
    s_cbranch_scc1 L_nf_5
    s_waitcnt vmcnt(0)
    v_mov_b32 v80, s52
    v_mov_b32 v81, s53
    v_mov_b32 v82, 0
    s_mov_b64 exec, 1
    buffer_store_dwordx2 v[80:81], v82, s[8:11], s46 offen sc1
    s_mov_b64 exec, -1
L_nf_5:
    s_barrier
    ds_read_b64_tr_b16 v[16:17], v12 offset:16896
    ds_read_b64_tr_b16 v[18:19], v12 offset:17152
    s_waitcnt lgkmcnt(6)
    v_mfma_f32_32x32x16_bf16 v[48:63], v[20:23], a[20:23], v[48:63]
    ds_write_b128 v110, v[106:109]
    s_lshl_b32 s3, s31, 13
    v_lshlrev_b32 v96, 4, v1
    v_add_u32 v96, s3, v96
    ds_read_b64_tr_b16 v[20:21], v12 offset:17920
    ds_read_b64_tr_b16 v[22:23], v12 offset:18176
    s_waitcnt lgkmcnt(6)
    v_mfma_f32_32x32x16_bf16 v[48:63], v[24:27], a[24:27], v[48:63]
    v_and_b32 v106, 31, v1
    v_lshrrev_b32 v107, 5, v1
    v_lshlrev_b32 v107, 8, v107
    v_lshl_add_u32 v107, v106, 4, v107
    ds_read_b64_tr_b16 v[24:25], v12 offset:18944
    ds_read_b64_tr_b16 v[26:27], v12 offset:19200
    s_waitcnt lgkmcnt(6)
    v_mfma_f32_32x32x16_bf16 v[48:63], v[28:31], a[28:31], v[48:63]
    v_add_u32 v107, s3, v107
    v_mov_b32 v108, 152768
    v_mov_b32 v111, 152640
    v_subrev_u32 v109, 20, v106
    ds_read_b64_tr_b16 v[28:29], v12 offset:19968
    ds_read_b64_tr_b16 v[30:31], v12 offset:20224
    s_waitcnt lgkmcnt(6)
    v_mfma_f32_32x32x16_bf16 v[48:63], v[16:19], a[32:35], v[48:63]
    v_cmp_gt_u32 vcc, 8, v109
    s_nop 1
    v_cndmask_b32 v108, v108, v111, vcc
    v_mov_b32 v111, 152576
    ds_read_b64_tr_b16 v[16:17], v12 offset:25152
    ds_read_b64_tr_b16 v[18:19], v12 offset:25408
    s_waitcnt lgkmcnt(6)
    v_mfma_f32_32x32x16_bf16 v[48:63], v[20:23], a[36:39], v[48:63]
    v_cmp_eq_u32 vcc, 16, v106
    s_nop 1
    v_cndmask_b32 v108, v108, v111, vcc
    v_cmp_gt_u32 vcc, 16, v106
    ds_read_b64_tr_b16 v[20:21], v12 offset:26176
    ds_read_b64_tr_b16 v[22:23], v12 offset:26432
    s_waitcnt lgkmcnt(6)
    v_mfma_f32_32x32x16_bf16 v[48:63], v[24:27], a[40:43], v[48:63]
    s_nop 1
    v_add_u32 v109, 1024, v107
    v_cndmask_b32 v97, v108, v109, vcc
    v_add_u32 v109, 17408, v107
    ds_read_b64_tr_b16 v[24:25], v12 offset:27200
    ds_read_b64_tr_b16 v[26:27], v12 offset:27456
    s_waitcnt lgkmcnt(6)
    v_mfma_f32_32x32x16_bf16 v[48:63], v[28:31], a[44:47], v[48:63]
    v_cndmask_b32 v98, v108, v109, vcc
    v_add_u32 v109, 33792, v107
    v_cndmask_b32 v99, v108, v109, vcc
    v_add_u32 v109, 50176, v107
    ds_read_b64_tr_b16 v[28:29], v12 offset:28224
    ds_read_b64_tr_b16 v[30:31], v12 offset:28480
    s_waitcnt lgkmcnt(6)
    v_mfma_f32_32x32x16_bf16 v[48:63], v[16:19], a[48:51], v[48:63]
    v_cndmask_b32 v100, v108, v109, vcc
    s_lshl_b32 s3, s33, 16
    s_lshl_b32 s4, s34, 10
    s_add_u32 s3, s3, s4
    s_barrier
    ds_read_b64_tr_b16 v[16:17], v12 offset:33792
    ds_read_b64_tr_b16 v[18:19], v12 offset:34048
    s_waitcnt lgkmcnt(6)
    v_mfma_f32_32x32x16_bf16 v[48:63], v[20:23], a[52:55], v[48:63]
    v_lshlrev_b32 v104, 4, v1
    v_add_u32 v104, s3, v104
    s_and_b32 s24, s2, 7
    s_lshr_b32 s25, s2, 3
    ds_read_b64_tr_b16 v[20:21], v12 offset:34816
    ds_read_b64_tr_b16 v[22:23], v12 offset:35072
    s_waitcnt lgkmcnt(6)
    v_mfma_f32_32x32x16_bf16 v[48:63], v[24:27], a[56:59], v[48:63]
    s_and_b32 s26, s25, 3
    s_lshl_b32 s24, s24, 2
    s_add_u32 s66, s24, s26
    s_lshr_b32 s67, s25, 2
    ds_read_b64_tr_b16 v[24:25], v12 offset:35840
    ds_read_b64_tr_b16 v[26:27], v12 offset:36096
    s_waitcnt lgkmcnt(6)
    v_mfma_f32_32x32x16_bf16 v[48:63], v[28:31], a[60:63], v[48:63]
    s_mov_b32 s68, s90
    s_and_b32 s69, s91, 0xffff
    s_mov_b32 s70, 524288
    s_mov_b32 s71, 0x00020000
    ds_read_b64_tr_b16 v[28:29], v12 offset:36864
    ds_read_b64_tr_b16 v[30:31], v12 offset:37120
    s_waitcnt lgkmcnt(6)
    v_mfma_f32_32x32x16_bf16 v[48:63], v[16:19], a[64:67], v[48:63]
    s_mov_b32 s76, s100
    s_and_b32 s77, s101, 0xffff
    s_mov_b32 s78, 524288
    s_mov_b32 s79, 0x00020000
    ds_read_b64_tr_b16 v[16:17], v12 offset:42048
    ds_read_b64_tr_b16 v[18:19], v12 offset:42304
    s_waitcnt lgkmcnt(6)
    v_mfma_f32_32x32x16_bf16 v[48:63], v[20:23], a[68:71], v[48:63]
    s_mov_b32 s72, s94
    s_and_b32 s73, s95, 0xffff
    s_mov_b32 s74, 2097152
    s_mov_b32 s75, 0x00020000
    ds_read_b64_tr_b16 v[20:21], v12 offset:43072
    ds_read_b64_tr_b16 v[22:23], v12 offset:43328
    s_waitcnt lgkmcnt(6)
    v_mfma_f32_32x32x16_bf16 v[48:63], v[24:27], a[72:75], v[48:63]
    s_lshr_b32 s3, s30, 1
    s_lshl_b32 s3, s3, 19
    s_lshl_b32 s4, s66, 11
    s_add_u32 s3, s3, s4
    ds_read_b64_tr_b16 v[24:25], v12 offset:44096
    ds_read_b64_tr_b16 v[26:27], v12 offset:44352
    s_waitcnt lgkmcnt(6)
    v_mfma_f32_32x32x16_bf16 v[48:63], v[28:31], a[76:79], v[48:63]
    s_and_b32 s4, s30, 1
    s_lshl_b32 s4, s4, 10
    s_add_u32 s3, s3, s4
    v_lshlrev_b32 v125, 4, v1
    ds_read_b64_tr_b16 v[28:29], v12 offset:45120
    ds_read_b64_tr_b16 v[30:31], v12 offset:45376
    s_waitcnt lgkmcnt(6)
    v_mfma_f32_32x32x16_bf16 v[48:63], v[16:19], a[80:83], v[48:63]
    v_add_u32 v125, s3, v125
    v_lshrrev_b32 v106, 3, v1
    v_add_u32 v106, 0, v106
    v_bfe_u32 v107, v106, 1, 1
    s_barrier
    ds_read_b64_tr_b16 v[16:17], v12 offset:50688
    ds_read_b64_tr_b16 v[18:19], v12 offset:50944
    s_waitcnt lgkmcnt(6)
    v_mfma_f32_32x32x16_bf16 v[48:63], v[20:23], a[84:87], v[48:63]
    v_lshlrev_b32 v107, 2, v107
    v_and_b32 v108, 7, v1
    v_xor_b32 v107, v107, v108
    v_lshlrev_b32 v106, 10, v106
    ds_read_b64_tr_b16 v[20:21], v12 offset:51712
    ds_read_b64_tr_b16 v[22:23], v12 offset:51968
    s_waitcnt lgkmcnt(6)
    v_mfma_f32_32x32x16_bf16 v[48:63], v[24:27], a[88:91], v[48:63]
    v_lshl_add_u32 v106, v107, 4, v106
    s_lshl_b32 s3, s67, 7
    v_add_u32 v126, s3, v106
    v_lshrrev_b32 v106, 3, v1
    ds_read_b64_tr_b16 v[24:25], v12 offset:52736
    ds_read_b64_tr_b16 v[26:27], v12 offset:52992
    s_waitcnt lgkmcnt(6)
    v_mfma_f32_32x32x16_bf16 v[48:63], v[28:31], a[92:95], v[48:63]
    v_add_u32 v106, 8, v106
    v_bfe_u32 v107, v106, 1, 1
    v_lshlrev_b32 v107, 2, v107
    v_and_b32 v108, 7, v1
    ds_read_b64_tr_b16 v[28:29], v12 offset:53760
    ds_read_b64_tr_b16 v[30:31], v12 offset:54016
    s_waitcnt lgkmcnt(6)
    v_mfma_f32_32x32x16_bf16 v[48:63], v[16:19], a[96:99], v[48:63]
    v_xor_b32 v107, v107, v108
    v_lshlrev_b32 v106, 10, v106
    v_lshl_add_u32 v106, v107, 4, v106
    s_lshl_b32 s3, s67, 7
    ds_read_b64_tr_b16 v[16:17], v12 offset:58944
    ds_read_b64_tr_b16 v[18:19], v12 offset:59200
    s_waitcnt lgkmcnt(6)
    v_mfma_f32_32x32x16_bf16 v[48:63], v[20:23], a[100:103], v[48:63]
    v_add_u32 v127, s3, v106
    v_lshrrev_b32 v106, 5, v1
    v_bfe_u32 v107, v1, 2, 2
    v_lshl_add_u32 v106, v106, 2, v107
    ds_read_b64_tr_b16 v[20:21], v12 offset:59968
    ds_read_b64_tr_b16 v[22:23], v12 offset:60224
    s_waitcnt lgkmcnt(6)
    v_mfma_f32_32x32x16_bf16 v[48:63], v[24:27], a[104:107], v[48:63]
    v_lshlrev_b32 v106, 7, v106
    v_bfe_u32 v107, v1, 3, 1
    v_lshl_add_u32 v106, v107, 6, v106
    v_bfe_u32 v107, v1, 4, 1
    ds_read_b64_tr_b16 v[24:25], v12 offset:60992
    ds_read_b64_tr_b16 v[26:27], v12 offset:61248
    s_waitcnt lgkmcnt(6)
    v_mfma_f32_32x32x16_bf16 v[48:63], v[28:31], a[108:111], v[48:63]
    v_lshl_add_u32 v106, v107, 5, v106
    v_and_b32 v107, 3, v1
    v_lshl_add_u32 v106, v107, 3, v106
    s_lshr_b32 s3, s30, 1
    ds_read_b64_tr_b16 v[28:29], v12 offset:62016
    ds_read_b64_tr_b16 v[30:31], v12 offset:62272
    s_waitcnt lgkmcnt(6)
    v_mfma_f32_32x32x16_bf16 v[48:63], v[16:19], a[112:115], v[48:63]
    s_lshl_b32 s3, s3, 14
    v_add_u32 v124, s3, v106
    s_barrier
    ds_read_b64_tr_b16 v[16:17], v14 offset:0
    ds_read_b64_tr_b16 v[18:19], v14 offset:256
    s_waitcnt lgkmcnt(6)
    v_mfma_f32_32x32x16_bf16 v[48:63], v[20:23], a[116:119], v[48:63]
    s_lshl_b32 s3, s32, 11
    v_lshlrev_b32 v101, 4, v1
    v_add_u32 v101, s3, v101
    ds_read_b64_tr_b16 v[20:21], v14 offset:1024
    ds_read_b64_tr_b16 v[22:23], v14 offset:1280
    s_waitcnt lgkmcnt(6)
    v_mfma_f32_32x32x16_bf16 v[48:63], v[24:27], a[120:123], v[48:63]
    s_lshl_b32 s4, s33, 17
    s_add_u32 s37, s4, 2097152
    s_mov_b32 s35, 8388608
    ds_read_b64_tr_b16 v[24:25], v14 offset:2048
    ds_read_b64_tr_b16 v[26:27], v14 offset:2304
    s_waitcnt lgkmcnt(6)
    v_mfma_f32_32x32x16_bf16 v[48:63], v[28:31], a[124:127], v[48:63]
    s_mov_b32 s36, 8519680
    s_mov_b32 s51, 8388608
    s_mov_b32 s50, 9437184
    ds_read_b64_tr_b16 v[28:29], v14 offset:3072
    ds_read_b64_tr_b16 v[30:31], v14 offset:3328
    s_waitcnt lgkmcnt(6)
    v_mfma_f32_32x32x16_bf16 v[64:79], v[16:19], a[0:3], 0
    s_lshl_b32 s39, s30, 11
    v_and_b32 v2, 31, v1
    s_lshl_b32 s4, s34, 7
    ds_read_b64_tr_b16 v[16:17], v14 offset:8256
    ds_read_b64_tr_b16 v[18:19], v14 offset:8512
    s_waitcnt lgkmcnt(6)
    v_mfma_f32_32x32x16_bf16 v[64:79], v[20:23], a[4:7], v[64:79]
    v_lshlrev_b32 v2, 2, v2
    s_add_u32 s4, s4, 8519680
    v_add_u32 v2, s4, v2
    ds_read_b64_tr_b16 v[20:21], v14 offset:9280
    ds_read_b64_tr_b16 v[22:23], v14 offset:9536
    s_waitcnt lgkmcnt(6)
    v_mfma_f32_32x32x16_bf16 v[64:79], v[24:27], a[8:11], v[64:79]
    s_mov_b32 s56, 0
    s_mov_b32 s57, 0
    s_mov_b32 s58, 272
    ds_read_b64_tr_b16 v[24:25], v14 offset:10304
    ds_read_b64_tr_b16 v[26:27], v14 offset:10560
    s_waitcnt lgkmcnt(6)
    v_mfma_f32_32x32x16_bf16 v[64:79], v[28:31], a[12:15], v[64:79]
    s_cmp_eq_u32 s30, 0
    s_cselect_b32 s92, 17, 0
    s_cselect_b32 s93, 36, 0
    ds_read_b64_tr_b16 v[28:29], v14 offset:11328
    ds_read_b64_tr_b16 v[30:31], v14 offset:11584
    s_waitcnt lgkmcnt(6)
    v_mfma_f32_32x32x16_bf16 v[64:79], v[16:19], a[16:19], v[64:79]
    s_mov_b32 s89, 34
    s_mov_b32 s98, 112
    s_mov_b32 s99, 48
    s_barrier
    ds_read_b64_tr_b16 v[16:17], v14 offset:16896
    ds_read_b64_tr_b16 v[18:19], v14 offset:17152
    s_waitcnt lgkmcnt(6)
    v_mfma_f32_32x32x16_bf16 v[64:79], v[20:23], a[20:23], v[64:79]
    s_lshl_b32 s26, s30, 13
    s_add_u32 s26, s26, 67584
    s_lshl_b32 s27, s30, 16
    ds_read_b64_tr_b16 v[20:21], v14 offset:17920
    ds_read_b64_tr_b16 v[22:23], v14 offset:18176
    s_waitcnt lgkmcnt(6)
    v_mfma_f32_32x32x16_bf16 v[64:79], v[24:27], a[24:27], v[64:79]
    s_mov_b32 s12, s68
    s_mov_b32 s13, s69
    s_mov_b32 s14, s70
    s_mov_b32 s15, s71
    ds_read_b64_tr_b16 v[24:25], v14 offset:18944
    ds_read_b64_tr_b16 v[26:27], v14 offset:19200
    s_waitcnt lgkmcnt(6)
    v_mfma_f32_32x32x16_bf16 v[64:79], v[28:31], a[28:31], v[64:79]
    s_lshl_b32 s88, s67, 7
    s_lshl_b32 s96, s29, 7
    s_lshl_b32 s4, s28, 3
    ds_read_b64_tr_b16 v[28:29], v14 offset:19968
    ds_read_b64_tr_b16 v[30:31], v14 offset:20224
    s_waitcnt lgkmcnt(6)
    v_mfma_f32_32x32x16_bf16 v[64:79], v[16:19], a[32:35], v[64:79]
    s_add_u32 s96, s96, s4
    s_add_u32 s96, s96, 15732736
    s_lshl_b32 s97, s29, 7
    ds_read_b64_tr_b16 v[16:17], v14 offset:25152
    ds_read_b64_tr_b16 v[18:19], v14 offset:25408
    s_waitcnt lgkmcnt(6)
    v_mfma_f32_32x32x16_bf16 v[64:79], v[20:23], a[36:39], v[64:79]
    s_add_u32 s97, s97, 15732736
    v_lshlrev_b32 v3, 10, v0
    ds_read_b64_tr_b16 v[20:21], v14 offset:26176
    ds_read_b64_tr_b16 v[22:23], v14 offset:26432
    s_waitcnt lgkmcnt(6)
    v_mfma_f32_32x32x16_bf16 v[64:79], v[24:27], a[40:43], v[64:79]
    ds_read_b64_tr_b16 v[24:25], v14 offset:27200
    ds_read_b64_tr_b16 v[26:27], v14 offset:27456
    s_waitcnt lgkmcnt(6)
    v_mfma_f32_32x32x16_bf16 v[64:79], v[28:31], a[44:47], v[64:79]
    ds_read_b64_tr_b16 v[28:29], v14 offset:28224
    ds_read_b64_tr_b16 v[30:31], v14 offset:28480
    s_waitcnt lgkmcnt(6)
    v_mfma_f32_32x32x16_bf16 v[64:79], v[16:19], a[48:51], v[64:79]
    s_cmp_eq_u32 s30, 0
    s_cbranch_scc0 L_nopoll1
    s_mov_b32 s59, 131072
    v_lshlrev_b32 v110, 4, v1
    s_mov_b32 s46, 15728640
L_poll1:
    buffer_load_dwordx4 v[106:109], v110, s[8:11], s46 offen sc1
    s_waitcnt vmcnt(0)
    v_xor_b32 v106, s52, v106
    v_xor_b32 v107, s53, v107
    v_xor_b32 v108, s52, v108
    v_xor_b32 v109, s53, v109
    v_or3_b32 v106, v106, v107, v108
    v_or_b32 v106, v106, v109
    v_cmp_ne_u32 vcc, 0, v106
    s_nop 4
    s_cbranch_vccz L_poll1_ok
    s_sub_u32 s59, s59, 1
    s_cmp_eq_u32 s59, 0
    s_cbranch_scc1 L_poll1_ok
    s_sleep 1
    s_branch L_poll1
L_poll1_ok:
L_nopoll1:
    s_barrier
    buffer_load_dword v103, v2, s[8:11], 0 offen sc1
    s_add_u32 m0, s39, 0
    s_nop 0
    buffer_load_dwordx4 v101, s[8:11], s35 offen sc1 lds
    s_add_u32 m0, s39, 0
    s_nop 0
    buffer_load_dwordx4 v101, s[8:11], s35 offen offset:1024 sc1 lds
    s_add_u32 s35, s35, 8192
    s_cmp_eq_u32 s35, s36
    s_cselect_b32 s35, s37, s35
    s_add_u32 m0, s39, 16384
    s_nop 0
    buffer_load_dwordx4 v101, s[8:11], s35 offen sc1 lds
    s_add_u32 m0, s39, 16384
    s_nop 0
    buffer_load_dwordx4 v101, s[8:11], s35 offen offset:1024 sc1 lds
    s_add_u32 s35, s35, 8192
    s_cmp_eq_u32 s35, s36
    s_cselect_b32 s35, s37, s35
    s_add_u32 m0, s39, 32768
    s_nop 0
    buffer_load_dwordx4 v101, s[8:11], s35 offen sc1 lds
    ds_read_b64_tr_b16 v[16:17], v14 offset:33792
    ds_read_b64_tr_b16 v[18:19], v14 offset:34048
    s_waitcnt lgkmcnt(6)
    v_mfma_f32_32x32x16_bf16 v[64:79], v[20:23], a[52:55], v[64:79]
    ds_read_b64_tr_b16 v[20:21], v14 offset:34816
    ds_read_b64_tr_b16 v[22:23], v14 offset:35072
    s_waitcnt lgkmcnt(6)
    v_mfma_f32_32x32x16_bf16 v[64:79], v[24:27], a[56:59], v[64:79]
    v_cvt_pk_bf16_f32 v32, v48, v49
    v_cvt_pk_bf16_f32 v33, v50, v51
    v_cvt_pk_bf16_f32 v34, v52, v53
    v_cvt_pk_bf16_f32 v35, v54, v55
    ds_read_b64_tr_b16 v[24:25], v14 offset:35840
    ds_read_b64_tr_b16 v[26:27], v14 offset:36096
    s_waitcnt lgkmcnt(6)
    v_mfma_f32_32x32x16_bf16 v[64:79], v[28:31], a[60:63], v[64:79]
    v_cvt_pk_bf16_f32 v36, v56, v57
    v_cvt_pk_bf16_f32 v37, v58, v59
    v_cvt_pk_bf16_f32 v38, v60, v61
    v_cvt_pk_bf16_f32 v39, v62, v63
    ds_read_b64_tr_b16 v[28:29], v14 offset:36864
    ds_read_b64_tr_b16 v[30:31], v14 offset:37120
    s_waitcnt lgkmcnt(6)
    v_mfma_f32_32x32x16_bf16 v[64:79], v[16:19], a[64:67], v[64:79]
    s_lshl_b32 s90, s29, 18
    s_lshl_b32 s91, s34, 11
    s_add_u32 s90, s90, s91
    s_add_u32 s90, s90, 2097152
    ds_read_b64_tr_b16 v[16:17], v14 offset:42048
    ds_read_b64_tr_b16 v[18:19], v14 offset:42304
    s_waitcnt lgkmcnt(6)
    v_mfma_f32_32x32x16_bf16 v[64:79], v[20:23], a[68:71], v[64:79]
    v_lshlrev_b32 v84, 4, v1
    s_add_u32 s91, s90, 131072
    buffer_store_dwordx4 v[32:35], v84, s[8:11], s90 offen sc1
    buffer_store_dwordx4 v[36:39], v84, s[8:11], s91 offen sc1
    v_lshlrev_b32 v8, 3, v1
    v_mov_b32 v10, s52
    v_mov_b32 v11, s53
    ds_read_b64_tr_b16 v[20:21], v14 offset:43072
    ds_read_b64_tr_b16 v[22:23], v14 offset:43328
    s_waitcnt lgkmcnt(6)
    v_mfma_f32_32x32x16_bf16 v[64:79], v[24:27], a[72:75], v[64:79]
    v_mov_b32 v6, s52
    v_mov_b32 v7, s53
    ds_read_b64_tr_b16 v[24:25], v14 offset:44096
    ds_read_b64_tr_b16 v[26:27], v14 offset:44352
    s_waitcnt lgkmcnt(6)
    v_mfma_f32_32x32x16_bf16 v[64:79], v[28:31], a[76:79], v[64:79]
    ds_read_b64_tr_b16 v[28:29], v14 offset:45120
    ds_read_b64_tr_b16 v[30:31], v14 offset:45376
    s_waitcnt lgkmcnt(6)
    v_mfma_f32_32x32x16_bf16 v[64:79], v[16:19], a[80:83], v[64:79]
    s_barrier
    ds_read_b64_tr_b16 v[16:17], v14 offset:50688
    ds_read_b64_tr_b16 v[18:19], v14 offset:50944
    s_waitcnt lgkmcnt(6)
    v_mfma_f32_32x32x16_bf16 v[64:79], v[20:23], a[84:87], v[64:79]
    ds_read_b64_tr_b16 v[20:21], v14 offset:51712
    ds_read_b64_tr_b16 v[22:23], v14 offset:51968
    s_waitcnt lgkmcnt(6)
    v_mfma_f32_32x32x16_bf16 v[64:79], v[24:27], a[88:91], v[64:79]
    ds_read_b64_tr_b16 v[24:25], v14 offset:52736
    ds_read_b64_tr_b16 v[26:27], v14 offset:52992
    s_waitcnt lgkmcnt(6)
    v_mfma_f32_32x32x16_bf16 v[64:79], v[28:31], a[92:95], v[64:79]
    ds_read_b64_tr_b16 v[28:29], v14 offset:53760
    ds_read_b64_tr_b16 v[30:31], v14 offset:54016
    s_waitcnt lgkmcnt(6)
    v_mfma_f32_32x32x16_bf16 v[64:79], v[16:19], a[96:99], v[64:79]
    ds_read_b64_tr_b16 v[16:17], v14 offset:58944
    ds_read_b64_tr_b16 v[18:19], v14 offset:59200
    s_waitcnt lgkmcnt(6)
    v_mfma_f32_32x32x16_bf16 v[64:79], v[20:23], a[100:103], v[64:79]
    ds_read_b64_tr_b16 v[20:21], v14 offset:59968
    ds_read_b64_tr_b16 v[22:23], v14 offset:60224
    s_waitcnt lgkmcnt(6)
    v_mfma_f32_32x32x16_bf16 v[64:79], v[24:27], a[104:107], v[64:79]
    ds_read_b64_tr_b16 v[24:25], v14 offset:60992
    ds_read_b64_tr_b16 v[26:27], v14 offset:61248
    s_waitcnt lgkmcnt(6)
    v_mfma_f32_32x32x16_bf16 v[64:79], v[28:31], a[108:111], v[64:79]
    ds_read_b64_tr_b16 v[28:29], v14 offset:62016
    ds_read_b64_tr_b16 v[30:31], v14 offset:62272
    s_waitcnt lgkmcnt(6)
    v_mfma_f32_32x32x16_bf16 v[64:79], v[16:19], a[112:115], v[64:79]
    s_waitcnt lgkmcnt(4)
    v_mfma_f32_32x32x16_bf16 v[64:79], v[20:23], a[116:119], v[64:79]
    s_waitcnt lgkmcnt(2)
    v_mfma_f32_32x32x16_bf16 v[64:79], v[24:27], a[120:123], v[64:79]
    s_waitcnt lgkmcnt(0)
    v_mfma_f32_32x32x16_bf16 v[64:79], v[28:31], a[124:127], v[64:79]
    s_nop 7
    s_nop 3
    v_mul_f32 v64, 0x3eb8aa3b, v64
    v_mul_f32 v65, 0x3eb8aa3b, v65
    v_mul_f32 v66, 0x3eb8aa3b, v66
    v_mul_f32 v67, 0x3eb8aa3b, v67
    v_mul_f32 v68, 0x3eb8aa3b, v68
    v_mul_f32 v69, 0x3eb8aa3b, v69
    v_mul_f32 v70, 0x3eb8aa3b, v70
    v_mul_f32 v71, 0x3eb8aa3b, v71
    v_mul_f32 v72, 0x3eb8aa3b, v72
    v_mul_f32 v73, 0x3eb8aa3b, v73
    v_mul_f32 v74, 0x3eb8aa3b, v74
    v_mul_f32 v75, 0x3eb8aa3b, v75
    v_mul_f32 v76, 0x3eb8aa3b, v76
    v_mul_f32 v77, 0x3eb8aa3b, v77
    v_mul_f32 v78, 0x3eb8aa3b, v78
    v_mul_f32 v79, 0x3eb8aa3b, v79
    v_cvt_pk_bf16_f32 v116, v64, v65
    v_cvt_pk_bf16_f32 v117, v66, v67
    v_cvt_pk_bf16_f32 v118, v68, v69
    v_cvt_pk_bf16_f32 v119, v70, v71
    v_cvt_pk_bf16_f32 v120, v72, v73
    v_cvt_pk_bf16_f32 v121, v74, v75
    v_cvt_pk_bf16_f32 v122, v76, v77
    v_cvt_pk_bf16_f32 v123, v78, v79
    s_branch L_f_done
L_f_V:
    s_lshl_b32 s45, s32, 10
    s_cmp_eq_u32 s47, 0
    s_cbranch_scc1 L_nod_6
    s_and_b32 s40, s29, 3
    s_cmp_eq_u32 s40, s32
    s_cbranch_scc1 L_nod_6_lead
    s_waitcnt vmcnt(16)
    s_barrier
    s_branch L_nod_6
L_nod_6_lead:
    s_waitcnt vmcnt(0)
    s_barrier
L_nod_6:
    s_waitcnt vmcnt(14) lgkmcnt(0)
    s_barrier
    ds_read_b128 a[0:3], v8 offset:0
    ds_read_b128 a[4:7], v9 offset:0
    ds_read_b128 a[8:11], v10 offset:0
    ds_read_b128 a[12:15], v11 offset:0
    s_waitcnt vmcnt(12) lgkmcnt(4)
    s_barrier
    ds_read_b128 a[16:19], v8 offset:16896
    ds_read_b128 a[20:23], v9 offset:16896
    ds_read_b128 a[24:27], v10 offset:16896
    ds_read_b128 a[28:31], v11 offset:16896
    s_waitcnt vmcnt(10) lgkmcnt(4)
    s_barrier
    ds_read_b128 a[32:35], v8 offset:33792
    ds_read_b128 a[36:39], v9 offset:33792
    ds_read_b128 a[40:43], v10 offset:33792
    ds_read_b128 a[44:47], v11 offset:33792
    s_mul_i32 s40, s80, 196608
    s_add_u32 m0, s45, 0
    s_add_u32 s40, s40, 1024
    buffer_load_dwordx4 v7, s[16:19], s40 offen lds
    s_mul_i32 s40, s80, 196608
    s_add_u32 m0, s45, 4096
    s_add_u32 s40, s40, 2048
    buffer_load_dwordx4 v7, s[16:19], s40 offen lds
    s_mul_i32 s40, s81, 196608
    s_add_u32 m0, s45, 8256
    s_add_u32 s40, s40, 1024
    buffer_load_dwordx4 v7, s[16:19], s40 offen lds
    s_mul_i32 s40, s81, 196608
    s_add_u32 m0, s45, 12352
    s_add_u32 s40, s40, 2048
    buffer_load_dwordx4 v7, s[16:19], s40 offen lds
    s_waitcnt vmcnt(12) lgkmcnt(4)
    s_barrier
    ds_read_b128 a[48:51], v8 offset:50688
    ds_read_b128 a[52:55], v9 offset:50688
    ds_read_b128 a[56:59], v10 offset:50688
    ds_read_b128 a[60:63], v11 offset:50688
    v_add_u32 v8, 67584, v8
    v_add_u32 v9, 67584, v9
    v_add_u32 v10, 67584, v10
    v_add_u32 v11, 67584, v11
    s_waitcnt vmcnt(10) lgkmcnt(4)
    s_barrier
    ds_read_b128 a[64:67], v8 offset:0
    ds_read_b128 a[68:71], v9 offset:0
    ds_read_b128 a[72:75], v10 offset:0
    ds_read_b128 a[76:79], v11 offset:0
    s_mul_i32 s40, s82, 196608
    s_add_u32 m0, s45, 16896
    s_add_u32 s40, s40, 1024
    buffer_load_dwordx4 v7, s[16:19], s40 offen lds
    s_mul_i32 s40, s82, 196608
    s_add_u32 m0, s45, 20992
    s_add_u32 s40, s40, 2048
    buffer_load_dwordx4 v7, s[16:19], s40 offen lds
    s_mul_i32 s40, s83, 196608
    s_add_u32 m0, s45, 25152
    s_add_u32 s40, s40, 1024
    buffer_load_dwordx4 v7, s[16:19], s40 offen lds
    s_mul_i32 s40, s83, 196608
    s_add_u32 m0, s45, 29248
    s_add_u32 s40, s40, 2048
    buffer_load_dwordx4 v7, s[16:19], s40 offen lds
    s_waitcnt vmcnt(12) lgkmcnt(4)
    s_barrier
    ds_read_b128 a[80:83], v8 offset:16896
    ds_read_b128 a[84:87], v9 offset:16896
    ds_read_b128 a[88:91], v10 offset:16896
    ds_read_b128 a[92:95], v11 offset:16896
    s_waitcnt vmcnt(10) lgkmcnt(4)
    s_barrier
    ds_read_b128 a[96:99], v8 offset:33792
    ds_read_b128 a[100:103], v9 offset:33792
    ds_read_b128 a[104:107], v10 offset:33792
    ds_read_b128 a[108:111], v11 offset:33792
    s_mul_i32 s40, s84, 196608
    s_add_u32 m0, s45, 33792
    s_add_u32 s40, s40, 1024
    buffer_load_dwordx4 v7, s[16:19], s40 offen lds
    s_mul_i32 s40, s84, 196608
    s_add_u32 m0, s45, 37888
    s_add_u32 s40, s40, 2048
    buffer_load_dwordx4 v7, s[16:19], s40 offen lds
    s_mul_i32 s40, s85, 196608
    s_add_u32 m0, s45, 42048
    s_add_u32 s40, s40, 1024
    buffer_load_dwordx4 v7, s[16:19], s40 offen lds
    s_mul_i32 s40, s85, 196608
    s_add_u32 m0, s45, 46144
    s_add_u32 s40, s40, 2048
    buffer_load_dwordx4 v7, s[16:19], s40 offen lds
    s_waitcnt vmcnt(12) lgkmcnt(4)
    s_barrier
    ds_read_b128 a[112:115], v8 offset:50688
    ds_read_b128 a[116:119], v9 offset:50688
    ds_read_b128 a[120:123], v10 offset:50688
    ds_read_b128 a[124:127], v11 offset:50688
    s_waitcnt lgkmcnt(0)
    s_barrier
    s_mul_i32 s40, s86, 196608
    s_add_u32 m0, s45, 50688
    s_add_u32 s40, s40, 1024
    buffer_load_dwordx4 v7, s[16:19], s40 offen lds
    s_mul_i32 s40, s86, 196608
    s_add_u32 m0, s45, 54784
    s_add_u32 s40, s40, 2048
    buffer_load_dwordx4 v7, s[16:19], s40 offen lds
    s_mul_i32 s40, s87, 196608
    s_add_u32 m0, s45, 58944
    s_add_u32 s40, s40, 1024
    buffer_load_dwordx4 v7, s[16:19], s40 offen lds
    s_mul_i32 s40, s87, 196608
    s_add_u32 m0, s45, 63040
    s_add_u32 s40, s40, 2048
    buffer_load_dwordx4 v7, s[16:19], s40 offen lds
    s_waitcnt vmcnt(12)
    s_barrier
    ds_read_b64_tr_b16 v[16:17], v12 offset:0
    ds_read_b64_tr_b16 v[18:19], v12 offset:256
    ds_read_b64_tr_b16 v[20:21], v12 offset:1024
    ds_read_b64_tr_b16 v[22:23], v12 offset:1280
    ds_read_b64_tr_b16 v[24:25], v12 offset:2048
    ds_read_b64_tr_b16 v[26:27], v12 offset:2304
    ds_read_b64_tr_b16 v[28:29], v12 offset:3072
    ds_read_b64_tr_b16 v[30:31], v12 offset:3328
    s_waitcnt lgkmcnt(6)
    v_mfma_f32_32x32x16_bf16 v[48:63], a[0:3], v[16:19], 0
    s_mul_i32 s40, s80, 65536
    s_add_u32 m0, s45, 67584
    s_nop 0
    buffer_load_dwordx4 v6, s[20:23], s40 offen lds
    ds_read_b64_tr_b16 v[16:17], v12 offset:8256
    ds_read_b64_tr_b16 v[18:19], v12 offset:8512
    s_waitcnt lgkmcnt(6)
    v_mfma_f32_32x32x16_bf16 v[48:63], a[4:7], v[20:23], v[48:63]
    v_and_b32 v106, 31, v0
    v_cmp_eq_u32 vcc, 0, v106
    v_mov_b32 v111, 0x3f803f80
    s_nop 0
    v_cndmask_b32 v106, 0, v111, vcc
    v_mov_b32 v107, v106
    v_mov_b32 v108, v106
    v_mov_b32 v109, v106
    ds_read_b64_tr_b16 v[20:21], v12 offset:9280
    ds_read_b64_tr_b16 v[22:23], v12 offset:9536
    s_waitcnt lgkmcnt(6)
    v_mfma_f32_32x32x16_bf16 v[48:63], a[8:11], v[24:27], v[48:63]
    s_mul_i32 s40, s80, 196608
    s_add_u32 m0, s45, 71712
    s_nop 0
    buffer_load_dwordx4 v7, s[16:19], s40 offen lds
    ds_read_b64_tr_b16 v[24:25], v12 offset:10304
    ds_read_b64_tr_b16 v[26:27], v12 offset:10560
    s_waitcnt lgkmcnt(6)
    v_mfma_f32_32x32x16_bf16 v[48:63], a[12:15], v[28:31], v[48:63]
    v_min_u32 v110, 447, v0
    v_cmp_gt_u32 vcc, 448, v0
    v_lshlrev_b32 v110, 4, v110
    v_add_u32 v110, 152576, v110
    v_cndmask_b32 v106, 0, v106, vcc
    v_cndmask_b32 v107, 0, v107, vcc
    v_cndmask_b32 v108, 0, v108, vcc
    v_cndmask_b32 v109, 0, v109, vcc
    ds_read_b64_tr_b16 v[28:29], v12 offset:11328
    ds_read_b64_tr_b16 v[30:31], v12 offset:11584
    s_waitcnt lgkmcnt(6)
    v_mfma_f32_32x32x16_bf16 v[48:63], a[16:19], v[16:19], v[48:63]
    s_mul_i32 s40, s81, 65536
    s_add_u32 m0, s45, 75840
    s_nop 0
    buffer_load_dwordx4 v6, s[20:23], s40 offen lds
    s_waitcnt vmcnt(11)
    s_barrier
    ds_read_b64_tr_b16 v[16:17], v12 offset:16896
    ds_read_b64_tr_b16 v[18:19], v12 offset:17152
    s_waitcnt lgkmcnt(6)
    v_mfma_f32_32x32x16_bf16 v[48:63], a[20:23], v[20:23], v[48:63]
    ds_write_b128 v110, v[106:109]
    s_lshl_b32 s3, s31, 13
    v_lshlrev_b32 v96, 4, v1
    v_add_u32 v96, s3, v96
    v_and_b32 v106, 31, v1
    v_lshrrev_b32 v107, 5, v1
    v_lshlrev_b32 v107, 8, v107
    v_lshl_add_u32 v107, v106, 4, v107
    ds_read_b64_tr_b16 v[20:21], v12 offset:17920
    ds_read_b64_tr_b16 v[22:23], v12 offset:18176
    s_waitcnt lgkmcnt(6)
    v_mfma_f32_32x32x16_bf16 v[48:63], a[24:27], v[24:27], v[48:63]
    s_mul_i32 s40, s81, 196608
    s_add_u32 m0, s45, 79968
    s_nop 0
    buffer_load_dwordx4 v7, s[16:19], s40 offen lds
    ds_read_b64_tr_b16 v[24:25], v12 offset:18944
    ds_read_b64_tr_b16 v[26:27], v12 offset:19200
    s_waitcnt lgkmcnt(6)
    v_mfma_f32_32x32x16_bf16 v[48:63], a[28:31], v[28:31], v[48:63]
    v_add_u32 v107, s3, v107
    v_mov_b32 v108, 152768
    v_mov_b32 v111, 152640
    v_subrev_u32 v109, 20, v106
    v_cmp_gt_u32 vcc, 8, v109
    s_nop 1
    v_cndmask_b32 v108, v108, v111, vcc
    v_mov_b32 v111, 152576
    ds_read_b64_tr_b16 v[28:29], v12 offset:19968
    ds_read_b64_tr_b16 v[30:31], v12 offset:20224
    s_waitcnt lgkmcnt(6)
    v_mfma_f32_32x32x16_bf16 v[48:63], a[32:35], v[16:19], v[48:63]
    s_mul_i32 s40, s82, 65536
    s_add_u32 m0, s45, 84480
    s_nop 0
    buffer_load_dwordx4 v6, s[20:23], s40 offen lds
    ds_read_b64_tr_b16 v[16:17], v12 offset:25152
    ds_read_b64_tr_b16 v[18:19], v12 offset:25408
    s_waitcnt lgkmcnt(6)
    v_mfma_f32_32x32x16_bf16 v[48:63], a[36:39], v[20:23], v[48:63]
    v_cmp_eq_u32 vcc, 16, v106
    s_nop 1
    v_cndmask_b32 v108, v108, v111, vcc
    v_cmp_gt_u32 vcc, 16, v106
    s_nop 1
    v_add_u32 v109, 1024, v107
    v_cndmask_b32 v97, v108, v109, vcc
    v_add_u32 v109, 17408, v107
    ds_read_b64_tr_b16 v[20:21], v12 offset:26176
    ds_read_b64_tr_b16 v[22:23], v12 offset:26432
    s_waitcnt lgkmcnt(6)
    v_mfma_f32_32x32x16_bf16 v[48:63], a[40:43], v[24:27], v[48:63]
    s_mul_i32 s40, s82, 196608
    s_add_u32 m0, s45, 88608
    s_nop 0
    buffer_load_dwordx4 v7, s[16:19], s40 offen lds
    ds_read_b64_tr_b16 v[24:25], v12 offset:27200
    ds_read_b64_tr_b16 v[26:27], v12 offset:27456
    s_waitcnt lgkmcnt(6)
    v_mfma_f32_32x32x16_bf16 v[48:63], a[44:47], v[28:31], v[48:63]
    v_cndmask_b32 v98, v108, v109, vcc
    v_add_u32 v109, 33792, v107
    v_cndmask_b32 v99, v108, v109, vcc
    v_add_u32 v109, 50176, v107
    v_cndmask_b32 v100, v108, v109, vcc
    s_lshl_b32 s3, s33, 16
    s_lshl_b32 s4, s34, 10
    s_add_u32 s3, s3, s4
    ds_read_b64_tr_b16 v[28:29], v12 offset:28224
    ds_read_b64_tr_b16 v[30:31], v12 offset:28480
    s_waitcnt lgkmcnt(6)
    v_mfma_f32_32x32x16_bf16 v[48:63], a[48:51], v[16:19], v[48:63]
    s_mul_i32 s40, s83, 65536
    s_add_u32 m0, s45, 92736
    s_nop 0
    buffer_load_dwordx4 v6, s[20:23], s40 offen lds
    s_waitcnt vmcnt(11)
    s_barrier
    ds_read_b64_tr_b16 v[16:17], v12 offset:33792
    ds_read_b64_tr_b16 v[18:19], v12 offset:34048
    s_waitcnt lgkmcnt(6)
    v_mfma_f32_32x32x16_bf16 v[48:63], a[52:55], v[20:23], v[48:63]
    v_lshlrev_b32 v104, 4, v1
    v_add_u32 v104, s3, v104
    s_and_b32 s24, s2, 7
    s_lshr_b32 s25, s2, 3
    s_and_b32 s26, s25, 3
    s_lshl_b32 s24, s24, 2
    s_add_u32 s66, s24, s26
    s_lshr_b32 s67, s25, 2
    ds_read_b64_tr_b16 v[20:21], v12 offset:34816
    ds_read_b64_tr_b16 v[22:23], v12 offset:35072
    s_waitcnt lgkmcnt(6)
    v_mfma_f32_32x32x16_bf16 v[48:63], a[56:59], v[24:27], v[48:63]
    s_mul_i32 s40, s83, 196608
    s_add_u32 m0, s45, 96864
    s_nop 0
    buffer_load_dwordx4 v7, s[16:19], s40 offen lds
    ds_read_b64_tr_b16 v[24:25], v12 offset:35840
    ds_read_b64_tr_b16 v[26:27], v12 offset:36096
    s_waitcnt lgkmcnt(6)
    v_mfma_f32_32x32x16_bf16 v[48:63], a[60:63], v[28:31], v[48:63]
    s_mov_b32 s68, s90
    s_and_b32 s69, s91, 0xffff
    s_mov_b32 s70, 524288
    s_mov_b32 s71, 0x00020000
    s_mov_b32 s76, s100
    s_and_b32 s77, s101, 0xffff
    s_mov_b32 s78, 524288
    s_mov_b32 s79, 0x00020000
    ds_read_b64_tr_b16 v[28:29], v12 offset:36864
    ds_read_b64_tr_b16 v[30:31], v12 offset:37120
    s_waitcnt lgkmcnt(6)
    v_mfma_f32_32x32x16_bf16 v[48:63], a[64:67], v[16:19], v[48:63]
    s_mul_i32 s40, s84, 65536
    s_add_u32 m0, s45, 101376
    s_nop 0
    buffer_load_dwordx4 v6, s[20:23], s40 offen lds
    ds_read_b64_tr_b16 v[16:17], v12 offset:42048
    ds_read_b64_tr_b16 v[18:19], v12 offset:42304
    s_waitcnt lgkmcnt(6)
    v_mfma_f32_32x32x16_bf16 v[48:63], a[68:71], v[20:23], v[48:63]
    s_mov_b32 s72, s94
    s_and_b32 s73, s95, 0xffff
    s_mov_b32 s74, 2097152
    s_mov_b32 s75, 0x00020000
    s_lshr_b32 s3, s30, 1
    s_lshl_b32 s3, s3, 19
    s_lshl_b32 s4, s66, 11
    s_add_u32 s3, s3, s4
    ds_read_b64_tr_b16 v[20:21], v12 offset:43072
    ds_read_b64_tr_b16 v[22:23], v12 offset:43328
    s_waitcnt lgkmcnt(6)
    v_mfma_f32_32x32x16_bf16 v[48:63], a[72:75], v[24:27], v[48:63]
    s_mul_i32 s40, s84, 196608
    s_add_u32 m0, s45, 105504
    s_nop 0
    buffer_load_dwordx4 v7, s[16:19], s40 offen lds
    ds_read_b64_tr_b16 v[24:25], v12 offset:44096
    ds_read_b64_tr_b16 v[26:27], v12 offset:44352
    s_waitcnt lgkmcnt(6)
    v_mfma_f32_32x32x16_bf16 v[48:63], a[76:79], v[28:31], v[48:63]
    s_and_b32 s4, s30, 1
    s_lshl_b32 s4, s4, 10
    s_add_u32 s3, s3, s4
    v_lshlrev_b32 v125, 4, v1
    v_add_u32 v125, s3, v125
    v_lshrrev_b32 v106, 3, v1
    v_add_u32 v106, 0, v106
    v_bfe_u32 v107, v106, 1, 1
    ds_read_b64_tr_b16 v[28:29], v12 offset:45120
    ds_read_b64_tr_b16 v[30:31], v12 offset:45376
    s_waitcnt lgkmcnt(6)
    v_mfma_f32_32x32x16_bf16 v[48:63], a[80:83], v[16:19], v[48:63]
    s_mul_i32 s40, s85, 65536
    s_add_u32 m0, s45, 109632
    s_nop 0
    buffer_load_dwordx4 v6, s[20:23], s40 offen lds
    s_waitcnt vmcnt(11)
    s_barrier
    ds_read_b64_tr_b16 v[16:17], v12 offset:50688
    ds_read_b64_tr_b16 v[18:19], v12 offset:50944
    s_waitcnt lgkmcnt(6)
    v_mfma_f32_32x32x16_bf16 v[48:63], a[84:87], v[20:23], v[48:63]
    v_lshlrev_b32 v107, 2, v107
    v_and_b32 v108, 7, v1
    v_xor_b32 v107, v107, v108
    v_lshlrev_b32 v106, 10, v106
    v_lshl_add_u32 v106, v107, 4, v106
    s_lshl_b32 s3, s67, 7
    v_add_u32 v126, s3, v106
    v_lshrrev_b32 v106, 3, v1
    ds_read_b64_tr_b16 v[20:21], v12 offset:51712
    ds_read_b64_tr_b16 v[22:23], v12 offset:51968
    s_waitcnt lgkmcnt(6)
    v_mfma_f32_32x32x16_bf16 v[48:63], a[88:91], v[24:27], v[48:63]
    s_mul_i32 s40, s85, 196608
    s_add_u32 m0, s45, 113760
    s_nop 0
    buffer_load_dwordx4 v7, s[16:19], s40 offen lds
    ds_read_b64_tr_b16 v[24:25], v12 offset:52736
    ds_read_b64_tr_b16 v[26:27], v12 offset:52992
    s_waitcnt lgkmcnt(6)
    v_mfma_f32_32x32x16_bf16 v[48:63], a[92:95], v[28:31], v[48:63]
    v_add_u32 v106, 8, v106
    v_bfe_u32 v107, v106, 1, 1
    v_lshlrev_b32 v107, 2, v107
    v_and_b32 v108, 7, v1
    v_xor_b32 v107, v107, v108
    v_lshlrev_b32 v106, 10, v106
    v_lshl_add_u32 v106, v107, 4, v106
    s_lshl_b32 s3, s67, 7
    ds_read_b64_tr_b16 v[28:29], v12 offset:53760
    ds_read_b64_tr_b16 v[30:31], v12 offset:54016
    s_waitcnt lgkmcnt(6)
    v_mfma_f32_32x32x16_bf16 v[48:63], a[96:99], v[16:19], v[48:63]
    s_mul_i32 s40, s86, 65536
    s_add_u32 m0, s45, 118272
    s_nop 0
    buffer_load_dwordx4 v6, s[20:23], s40 offen lds
    ds_read_b64_tr_b16 v[16:17], v12 offset:58944
    ds_read_b64_tr_b16 v[18:19], v12 offset:59200
    s_waitcnt lgkmcnt(6)
    v_mfma_f32_32x32x16_bf16 v[48:63], a[100:103], v[20:23], v[48:63]
    v_add_u32 v127, s3, v106
    v_lshrrev_b32 v106, 5, v1
    v_bfe_u32 v107, v1, 2, 2
    v_lshl_add_u32 v106, v106, 2, v107
    v_lshlrev_b32 v106, 7, v106
    v_bfe_u32 v107, v1, 3, 1
    v_lshl_add_u32 v106, v107, 6, v106
    v_bfe_u32 v107, v1, 4, 1
    ds_read_b64_tr_b16 v[20:21], v12 offset:59968
    ds_read_b64_tr_b16 v[22:23], v12 offset:60224
    s_waitcnt lgkmcnt(6)
    v_mfma_f32_32x32x16_bf16 v[48:63], a[104:107], v[24:27], v[48:63]
    s_mul_i32 s40, s86, 196608
    s_add_u32 m0, s45, 122400
    s_nop 0
    buffer_load_dwordx4 v7, s[16:19], s40 offen lds
    ds_read_b64_tr_b16 v[24:25], v12 offset:60992
    ds_read_b64_tr_b16 v[26:27], v12 offset:61248
    s_waitcnt lgkmcnt(6)
    v_mfma_f32_32x32x16_bf16 v[48:63], a[108:111], v[28:31], v[48:63]
    v_lshl_add_u32 v106, v107, 5, v106
    v_and_b32 v107, 3, v1
    v_lshl_add_u32 v106, v107, 3, v106
    s_lshr_b32 s3, s30, 1
    s_lshl_b32 s3, s3, 14
    v_add_u32 v124, s3, v106
    ds_read_b64_tr_b16 v[28:29], v12 offset:62016
    ds_read_b64_tr_b16 v[30:31], v12 offset:62272
    s_waitcnt lgkmcnt(6)
    v_mfma_f32_32x32x16_bf16 v[48:63], a[112:115], v[16:19], v[48:63]
    s_mul_i32 s40, s87, 65536
    s_add_u32 m0, s45, 126528
    s_nop 0
    buffer_load_dwordx4 v6, s[20:23], s40 offen lds
    s_waitcnt vmcnt(11)
    s_barrier
    ds_read_b64_tr_b16 v[16:17], v14 offset:0
    ds_read_b64_tr_b16 v[18:19], v14 offset:256
    s_waitcnt lgkmcnt(6)
    v_mfma_f32_32x32x16_bf16 v[48:63], a[116:119], v[20:23], v[48:63]
    s_lshl_b32 s3, s32, 11
    v_lshlrev_b32 v101, 4, v1
    v_add_u32 v101, s3, v101
    s_lshl_b32 s4, s33, 17
    s_add_u32 s37, s4, 2097152
    s_mov_b32 s35, 8388608
    ds_read_b64_tr_b16 v[20:21], v14 offset:1024
    ds_read_b64_tr_b16 v[22:23], v14 offset:1280
    s_waitcnt lgkmcnt(6)
    v_mfma_f32_32x32x16_bf16 v[48:63], a[120:123], v[24:27], v[48:63]
    s_mul_i32 s40, s87, 196608
    s_add_u32 m0, s45, 130656
    s_nop 0
    buffer_load_dwordx4 v7, s[16:19], s40 offen lds
    ds_read_b64_tr_b16 v[24:25], v14 offset:2048
    ds_read_b64_tr_b16 v[26:27], v14 offset:2304
    s_waitcnt lgkmcnt(6)
    v_mfma_f32_32x32x16_bf16 v[48:63], a[124:127], v[28:31], v[48:63]
    s_mov_b32 s36, 8519680
    s_mov_b32 s51, 8388608
    s_mov_b32 s50, 9437184
    s_lshl_b32 s39, s30, 11
    v_and_b32 v2, 31, v1
    s_lshl_b32 s4, s34, 7
    ds_read_b64_tr_b16 v[28:29], v14 offset:3072
    ds_read_b64_tr_b16 v[30:31], v14 offset:3328
    s_waitcnt lgkmcnt(6)
    v_mfma_f32_32x32x16_bf16 v[64:79], v[16:19], a[0:3], 0
    v_lshlrev_b32 v2, 2, v2
    s_add_u32 s4, s4, 8519680
    v_add_u32 v2, s4, v2
    s_mov_b32 s56, 0
    s_mov_b32 s57, 0
    s_mov_b32 s58, 272
    ds_read_b64_tr_b16 v[16:17], v14 offset:8256
    ds_read_b64_tr_b16 v[18:19], v14 offset:8512
    s_waitcnt lgkmcnt(6)
    v_mfma_f32_32x32x16_bf16 v[64:79], v[20:23], a[4:7], v[64:79]
    s_cmp_eq_u32 s30, 0
    s_cselect_b32 s92, 17, 0
    s_cselect_b32 s93, 36, 0
    s_mov_b32 s89, 34
    s_mov_b32 s98, 112
    s_mov_b32 s99, 48
    ds_read_b64_tr_b16 v[20:21], v14 offset:9280
    ds_read_b64_tr_b16 v[22:23], v14 offset:9536
    s_waitcnt lgkmcnt(6)
    v_mfma_f32_32x32x16_bf16 v[64:79], v[24:27], a[8:11], v[64:79]
    s_lshl_b32 s26, s30, 13
    s_add_u32 s26, s26, 67584
    s_lshl_b32 s27, s30, 16
    s_mov_b32 s12, s68
    s_mov_b32 s13, s69
    s_mov_b32 s14, s70
    s_mov_b32 s15, s71
    ds_read_b64_tr_b16 v[24:25], v14 offset:10304
    ds_read_b64_tr_b16 v[26:27], v14 offset:10560
    s_waitcnt lgkmcnt(6)
    v_mfma_f32_32x32x16_bf16 v[64:79], v[28:31], a[12:15], v[64:79]
    v_cvt_pk_bf16_f32 v32, v48, v49
    v_cvt_pk_bf16_f32 v33, v50, v51
    v_cvt_pk_bf16_f32 v34, v52, v53
    v_cvt_pk_bf16_f32 v35, v54, v55
    v_cvt_pk_bf16_f32 v36, v56, v57
    v_cvt_pk_bf16_f32 v37, v58, v59
    v_cvt_pk_bf16_f32 v38, v60, v61
    v_cvt_pk_bf16_f32 v39, v62, v63
    ds_read_b64_tr_b16 v[28:29], v14 offset:11328
    ds_read_b64_tr_b16 v[30:31], v14 offset:11584
    s_waitcnt lgkmcnt(6)
    v_mfma_f32_32x32x16_bf16 v[64:79], v[16:19], a[16:19], v[64:79]
    s_lshl_b32 s90, s29, 18
    s_lshl_b32 s91, s34, 11
    s_add_u32 s90, s90, s91
    s_add_u32 s90, s90, 2097152
    v_bfe_u32 v84, v1, 4, 1
    v_lshlrev_b32 v84, 17, v84
    v_lshrrev_b32 v85, 5, v1
    v_lshl_add_u32 v84, v85, 8, v84
    s_waitcnt vmcnt(8)
    s_barrier
    ds_read_b64_tr_b16 v[16:17], v14 offset:16896
    ds_read_b64_tr_b16 v[18:19], v14 offset:17152
    s_waitcnt lgkmcnt(6)
    v_mfma_f32_32x32x16_bf16 v[64:79], v[20:23], a[20:23], v[64:79]
    v_and_b32 v85, 15, v1
    v_lshl_add_u32 v84, v85, 4, v84
    buffer_store_dwordx4 v[32:35], v84, s[8:11], s90 offen offset:1024 sc1
    buffer_store_dwordx4 v[36:39], v84, s[8:11], s90 offen offset:1536 sc1
    ds_read_b64_tr_b16 v[20:21], v14 offset:17920
    ds_read_b64_tr_b16 v[22:23], v14 offset:18176
    s_waitcnt lgkmcnt(6)
    v_mfma_f32_32x32x16_bf16 v[64:79], v[24:27], a[24:27], v[64:79]
    s_lshl_b32 s88, s67, 7
    s_lshl_b32 s96, s29, 7
    s_lshl_b32 s4, s28, 3
    s_add_u32 s96, s96, s4
    s_add_u32 s96, s96, 15732736
    s_lshl_b32 s97, s29, 7
    ds_read_b64_tr_b16 v[24:25], v14 offset:18944
    ds_read_b64_tr_b16 v[26:27], v14 offset:19200
    s_waitcnt lgkmcnt(6)
    v_mfma_f32_32x32x16_bf16 v[64:79], v[28:31], a[28:31], v[64:79]
    s_add_u32 s97, s97, 15732736
    v_lshlrev_b32 v3, 10, v0
    ds_read_b64_tr_b16 v[28:29], v14 offset:19968
    ds_read_b64_tr_b16 v[30:31], v14 offset:20224
    s_waitcnt lgkmcnt(6)
    v_mfma_f32_32x32x16_bf16 v[64:79], v[16:19], a[32:35], v[64:79]
    ds_read_b64_tr_b16 v[16:17], v14 offset:25152
    ds_read_b64_tr_b16 v[18:19], v14 offset:25408
    s_waitcnt lgkmcnt(6)
    v_mfma_f32_32x32x16_bf16 v[64:79], v[20:23], a[36:39], v[64:79]
    ds_read_b64_tr_b16 v[20:21], v14 offset:26176
    ds_read_b64_tr_b16 v[22:23], v14 offset:26432
    s_waitcnt lgkmcnt(6)
    v_mfma_f32_32x32x16_bf16 v[64:79], v[24:27], a[40:43], v[64:79]
    ds_read_b64_tr_b16 v[24:25], v14 offset:27200
    ds_read_b64_tr_b16 v[26:27], v14 offset:27456
    s_waitcnt lgkmcnt(6)
    v_mfma_f32_32x32x16_bf16 v[64:79], v[28:31], a[44:47], v[64:79]
    ds_read_b64_tr_b16 v[28:29], v14 offset:28224
    ds_read_b64_tr_b16 v[30:31], v14 offset:28480
    s_waitcnt lgkmcnt(6)
    v_mfma_f32_32x32x16_bf16 v[64:79], v[16:19], a[48:51], v[64:79]
    s_waitcnt vmcnt(6)
    s_barrier
    buffer_load_dword v103, v2, s[8:11], 0 offen sc1
    s_add_u32 m0, s39, 0
    s_nop 0
    buffer_load_dwordx4 v101, s[8:11], s35 offen sc1 lds
    s_add_u32 m0, s39, 0
    s_nop 0
    buffer_load_dwordx4 v101, s[8:11], s35 offen offset:1024 sc1 lds
    s_add_u32 s35, s35, 8192
    s_cmp_eq_u32 s35, s36
    s_cselect_b32 s35, s37, s35
    s_add_u32 m0, s39, 16384
    s_nop 0
    buffer_load_dwordx4 v101, s[8:11], s35 offen sc1 lds
    s_add_u32 m0, s39, 16384
    s_nop 0
    buffer_load_dwordx4 v101, s[8:11], s35 offen offset:1024 sc1 lds
    s_add_u32 s35, s35, 8192
    s_cmp_eq_u32 s35, s36
    s_cselect_b32 s35, s37, s35
    s_add_u32 m0, s39, 32768
    s_nop 0
    buffer_load_dwordx4 v101, s[8:11], s35 offen sc1 lds
    ds_read_b64_tr_b16 v[16:17], v14 offset:33792
    ds_read_b64_tr_b16 v[18:19], v14 offset:34048
    s_waitcnt lgkmcnt(6)
    v_mfma_f32_32x32x16_bf16 v[64:79], v[20:23], a[52:55], v[64:79]
    ds_read_b64_tr_b16 v[20:21], v14 offset:34816
    ds_read_b64_tr_b16 v[22:23], v14 offset:35072
    s_waitcnt lgkmcnt(6)
    v_mfma_f32_32x32x16_bf16 v[64:79], v[24:27], a[56:59], v[64:79]
    v_lshlrev_b32 v8, 3, v1
    v_mov_b32 v10, s52
    v_mov_b32 v11, s53
    ds_read_b64_tr_b16 v[24:25], v14 offset:35840
    ds_read_b64_tr_b16 v[26:27], v14 offset:36096
    s_waitcnt lgkmcnt(6)
    v_mfma_f32_32x32x16_bf16 v[64:79], v[28:31], a[60:63], v[64:79]
    v_mov_b32 v6, s52
    v_mov_b32 v7, s53
    ds_read_b64_tr_b16 v[28:29], v14 offset:36864
    ds_read_b64_tr_b16 v[30:31], v14 offset:37120
    s_waitcnt lgkmcnt(6)
    v_mfma_f32_32x32x16_bf16 v[64:79], v[16:19], a[64:67], v[64:79]
    ds_read_b64_tr_b16 v[16:17], v14 offset:42048
    ds_read_b64_tr_b16 v[18:19], v14 offset:42304
    s_waitcnt lgkmcnt(6)
    v_mfma_f32_32x32x16_bf16 v[64:79], v[20:23], a[68:71], v[64:79]
    ds_read_b64_tr_b16 v[20:21], v14 offset:43072
    ds_read_b64_tr_b16 v[22:23], v14 offset:43328
    s_waitcnt lgkmcnt(6)
    v_mfma_f32_32x32x16_bf16 v[64:79], v[24:27], a[72:75], v[64:79]
    ds_read_b64_tr_b16 v[24:25], v14 offset:44096
    ds_read_b64_tr_b16 v[26:27], v14 offset:44352
    s_waitcnt lgkmcnt(6)
    v_mfma_f32_32x32x16_bf16 v[64:79], v[28:31], a[76:79], v[64:79]
    ds_read_b64_tr_b16 v[28:29], v14 offset:45120
    ds_read_b64_tr_b16 v[30:31], v14 offset:45376
    s_waitcnt lgkmcnt(6)
    v_mfma_f32_32x32x16_bf16 v[64:79], v[16:19], a[80:83], v[64:79]
    s_waitcnt vmcnt(8)
    s_barrier
    ds_read_b64_tr_b16 v[16:17], v14 offset:50688
    ds_read_b64_tr_b16 v[18:19], v14 offset:50944
    s_waitcnt lgkmcnt(6)
    v_mfma_f32_32x32x16_bf16 v[64:79], v[20:23], a[84:87], v[64:79]
    ds_read_b64_tr_b16 v[20:21], v14 offset:51712
    ds_read_b64_tr_b16 v[22:23], v14 offset:51968
    s_waitcnt lgkmcnt(6)
    v_mfma_f32_32x32x16_bf16 v[64:79], v[24:27], a[88:91], v[64:79]
    ds_read_b64_tr_b16 v[24:25], v14 offset:52736
    ds_read_b64_tr_b16 v[26:27], v14 offset:52992
    s_waitcnt lgkmcnt(6)
    v_mfma_f32_32x32x16_bf16 v[64:79], v[28:31], a[92:95], v[64:79]
    ds_read_b64_tr_b16 v[28:29], v14 offset:53760
    ds_read_b64_tr_b16 v[30:31], v14 offset:54016
    s_waitcnt lgkmcnt(6)
    v_mfma_f32_32x32x16_bf16 v[64:79], v[16:19], a[96:99], v[64:79]
    ds_read_b64_tr_b16 v[16:17], v14 offset:58944
    ds_read_b64_tr_b16 v[18:19], v14 offset:59200
    s_waitcnt lgkmcnt(6)
    v_mfma_f32_32x32x16_bf16 v[64:79], v[20:23], a[100:103], v[64:79]
    ds_read_b64_tr_b16 v[20:21], v14 offset:59968
    ds_read_b64_tr_b16 v[22:23], v14 offset:60224
    s_waitcnt lgkmcnt(6)
    v_mfma_f32_32x32x16_bf16 v[64:79], v[24:27], a[104:107], v[64:79]
    ds_read_b64_tr_b16 v[24:25], v14 offset:60992
    ds_read_b64_tr_b16 v[26:27], v14 offset:61248
    s_waitcnt lgkmcnt(6)
    v_mfma_f32_32x32x16_bf16 v[64:79], v[28:31], a[108:111], v[64:79]
    ds_read_b64_tr_b16 v[28:29], v14 offset:62016
    ds_read_b64_tr_b16 v[30:31], v14 offset:62272
    s_waitcnt lgkmcnt(6)
    v_mfma_f32_32x32x16_bf16 v[64:79], v[16:19], a[112:115], v[64:79]
    s_waitcnt lgkmcnt(4)
    v_mfma_f32_32x32x16_bf16 v[64:79], v[20:23], a[116:119], v[64:79]
    s_waitcnt lgkmcnt(2)
    v_mfma_f32_32x32x16_bf16 v[64:79], v[24:27], a[120:123], v[64:79]
    s_waitcnt lgkmcnt(0)
    v_mfma_f32_32x32x16_bf16 v[64:79], v[28:31], a[124:127], v[64:79]
    s_nop 7
    s_nop 3
    v_mul_f32 v64, 0x3eb8aa3b, v64
    v_mul_f32 v65, 0x3eb8aa3b, v65
    v_mul_f32 v66, 0x3eb8aa3b, v66
    v_mul_f32 v67, 0x3eb8aa3b, v67
    v_mul_f32 v68, 0x3eb8aa3b, v68
    v_mul_f32 v69, 0x3eb8aa3b, v69
    v_mul_f32 v70, 0x3eb8aa3b, v70
    v_mul_f32 v71, 0x3eb8aa3b, v71
    v_mul_f32 v72, 0x3eb8aa3b, v72
    v_mul_f32 v73, 0x3eb8aa3b, v73
    v_mul_f32 v74, 0x3eb8aa3b, v74
    v_mul_f32 v75, 0x3eb8aa3b, v75
    v_mul_f32 v76, 0x3eb8aa3b, v76
    v_mul_f32 v77, 0x3eb8aa3b, v77
    v_mul_f32 v78, 0x3eb8aa3b, v78
    v_mul_f32 v79, 0x3eb8aa3b, v79
    v_cvt_pk_bf16_f32 v116, v64, v65
    v_cvt_pk_bf16_f32 v117, v66, v67
    v_cvt_pk_bf16_f32 v118, v68, v69
    v_cvt_pk_bf16_f32 v119, v70, v71
    v_cvt_pk_bf16_f32 v120, v72, v73
    v_cvt_pk_bf16_f32 v121, v74, v75
    v_cvt_pk_bf16_f32 v122, v76, v77
    v_cvt_pk_bf16_f32 v123, v78, v79
L_f_done:
    s_mov_b64 vcc, 0
    s_waitcnt vmcnt(3) lgkmcnt(0)
    v_sub_f32 v102, 1.0, v103
    s_barrier
    s_mov_b32 s49, 0
    s_cmp_eq_u32 s31, 0
    s_cbranch_scc0 L_task_Y
    s_setprio 1
    ds_read_b128 v[44:47], v96 offset:0
    ds_read_b128 v[84:87], v96 offset:2048
    ds_read_b128 v[88:91], v97 offset:0
    v_mov_b32 v92, 0
    v_mov_b32 v93, 0
    v_mov_b32 v94, 0
    v_mov_b32 v95, 0
    s_waitcnt lgkmcnt(2)
    v_mfma_f32_32x32x16_bf16 v[28:43], v[44:47], v[116:119], 0
    s_nop 7
    s_nop 7
    v_mov_b32 v64, 0
    v_mov_b32 v65, 0
    v_mov_b32 v66, 0
    v_mov_b32 v67, 0
    v_max3_f32 v106, v28, v29, v30
    v_max3_f32 v107, v31, v32, v33
    v_max3_f32 v108, v34, v35, v36
    v_max3_f32 v109, v37, v38, v39
    v_max3_f32 v106, v106, v40, v41
    v_max3_f32 v107, v107, v42, v43
    v_max3_f32 v106, v106, v108, v109
    v_mfma_f32_32x32x16_bf16 v[68:83], v[92:95], v[64:67], 0
    v_max_f32 v106, v106, v107
    s_nop 0
    v_mov_b32 v107, v106
    s_nop 1
    v_permlane32_swap_b32 v106, v107
    s_nop 0
    v_max_f32 v106, v106, v107
    v_add_f32 v106, 0x42c80000, v106
    v_sub_f32 v12, 0, v106
    v_sub_f32 v13, 0, v106
    v_sub_f32 v14, 0, v106
    v_sub_f32 v15, 0, v106
    v_sub_f32 v16, 0, v106
    v_sub_f32 v17, 0, v106
    v_sub_f32 v18, 0, v106
    v_sub_f32 v19, 0, v106
    v_sub_f32 v20, 0, v106
    v_sub_f32 v21, 0, v106
    v_sub_f32 v22, 0, v106
    v_sub_f32 v23, 0, v106
    v_sub_f32 v24, 0, v106
    v_sub_f32 v25, 0, v106
    v_sub_f32 v26, 0, v106
    v_sub_f32 v27, 0, v106
    s_nop 1
    v_mfma_f32_32x32x16_bf16 v[28:43], v[44:47], v[116:119], v[12:27]
    s_nop 7
    s_nop 3
.p2align 6
L_loop_X:
    s_waitcnt lgkmcnt(0)
    v_exp_f32 v28, v28
    v_exp_f32 v29, v29
    v_mfma_f32_32x32x16_bf16 v[68:83], v[92:95], v[64:67], v[68:83]
    s_setprio 1
    v_exp_f32 v30, v30
    v_cvt_pk_bf16_f32 v60, v28, v29
    v_exp_f32 v31, v31
    v_exp_f32 v32, v32
    v_cvt_pk_bf16_f32 v61, v30, v31
    v_exp_f32 v33, v33
    v_exp_f32 v34, v34
    v_mfma_f32_32x32x16_bf16 v[44:59], v[84:87], v[116:119], v[12:27]
    v_cvt_pk_bf16_f32 v62, v32, v33
    v_exp_f32 v35, v35
    v_exp_f32 v36, v36
    v_cvt_pk_bf16_f32 v63, v34, v35
    v_exp_f32 v37, v37
    v_exp_f32 v38, v38
    v_mfma_f32_32x32x16_bf16 v[68:83], v[88:91], v[60:63], v[68:83]
    v_cvt_pk_bf16_f32 v64, v36, v37
    v_exp_f32 v39, v39
    v_exp_f32 v40, v40
    v_cvt_pk_bf16_f32 v65, v38, v39
    v_exp_f32 v41, v41
    v_exp_f32 v42, v42
    v_exp_f32 v43, v43
    v_cvt_pk_bf16_f32 v66, v40, v41
    v_cvt_pk_bf16_f32 v67, v42, v43
    s_setprio 0
    ds_read_b128 v[92:95], v97 offset:512
    ds_read_b128 v[84:87], v96 offset:4096
    ds_read_b128 v[88:91], v97 offset:2048
    s_add_u32 m0, s39, 32768
    s_nop 0
    buffer_load_dwordx4 v101, s[8:11], s35 offen offset:1024 sc1 lds
    s_add_u32 s35, s35, 8192
    s_cmp_eq_u32 s35, s36
    s_cselect_b32 s35, s37, s35
    s_waitcnt lgkmcnt(0)
    v_exp_f32 v44, v44
    v_exp_f32 v45, v45
    v_mfma_f32_32x32x16_bf16 v[68:83], v[92:95], v[64:67], v[68:83]
    s_setprio 1
    v_exp_f32 v46, v46
    v_cvt_pk_bf16_f32 v60, v44, v45
    v_exp_f32 v47, v47
    v_exp_f32 v48, v48
    v_cvt_pk_bf16_f32 v61, v46, v47
    v_exp_f32 v49, v49
    v_exp_f32 v50, v50
    v_mfma_f32_32x32x16_bf16 v[28:43], v[84:87], v[116:119], v[12:27]
    v_cvt_pk_bf16_f32 v62, v48, v49
    v_exp_f32 v51, v51
    v_exp_f32 v52, v52
    v_cvt_pk_bf16_f32 v63, v50, v51
    v_exp_f32 v53, v53
    v_exp_f32 v54, v54
    v_mfma_f32_32x32x16_bf16 v[68:83], v[88:91], v[60:63], v[68:83]
    v_cvt_pk_bf16_f32 v64, v52, v53
    v_exp_f32 v55, v55
    v_exp_f32 v56, v56
    v_cvt_pk_bf16_f32 v65, v54, v55
    v_exp_f32 v57, v57
    v_exp_f32 v58, v58
    v_exp_f32 v59, v59
    v_cvt_pk_bf16_f32 v66, v56, v57
    v_cvt_pk_bf16_f32 v67, v58, v59
    s_setprio 0
    ds_read_b128 v[92:95], v97 offset:2560
    ds_read_b128 v[84:87], v96 offset:6144
    ds_read_b128 v[88:91], v97 offset:4096
    s_bitcmp1_b32 s89, s57
    s_cselect_b64 exec, -1, 0
    buffer_load_dword v2, v3, s[12:15], s88 offen
    s_mov_b64 exec, -1
    s_waitcnt lgkmcnt(0)
    v_exp_f32 v28, v28
    v_exp_f32 v29, v29
    v_mfma_f32_32x32x16_bf16 v[68:83], v[92:95], v[64:67], v[68:83]
    s_setprio 1
    v_exp_f32 v30, v30
    v_cvt_pk_bf16_f32 v60, v28, v29
    v_exp_f32 v31, v31
    v_exp_f32 v32, v32
    v_cvt_pk_bf16_f32 v61, v30, v31
    v_exp_f32 v33, v33
    v_exp_f32 v34, v34
    v_mfma_f32_32x32x16_bf16 v[44:59], v[84:87], v[116:119], v[12:27]
    v_cvt_pk_bf16_f32 v62, v32, v33
    v_exp_f32 v35, v35
    v_exp_f32 v36, v36
    v_cvt_pk_bf16_f32 v63, v34, v35
    v_exp_f32 v37, v37
    v_exp_f32 v38, v38
    v_mfma_f32_32x32x16_bf16 v[68:83], v[88:91], v[60:63], v[68:83]
    v_cvt_pk_bf16_f32 v64, v36, v37
    v_exp_f32 v39, v39
    v_exp_f32 v40, v40
    v_cvt_pk_bf16_f32 v65, v38, v39
    v_exp_f32 v41, v41
    v_exp_f32 v42, v42
    v_exp_f32 v43, v43
    v_cvt_pk_bf16_f32 v66, v40, v41
    v_cvt_pk_bf16_f32 v67, v42, v43
    s_setprio 0
    s_waitcnt vmcnt(2)
    s_barrier
    ds_read_b128 v[92:95], v97 offset:4608
    ds_read_b128 v[84:87], v96 offset:16384
    ds_read_b128 v[88:91], v97 offset:6144
    s_add_u32 m0, s39, 49152
    s_nop 0
    buffer_load_dwordx4 v101, s[8:11], s35 offen sc1 lds
    s_waitcnt lgkmcnt(0)
    v_exp_f32 v44, v44
    v_exp_f32 v45, v45
    v_mfma_f32_32x32x16_bf16 v[68:83], v[92:95], v[64:67], v[68:83]
    s_setprio 1
    v_exp_f32 v46, v46
    v_cvt_pk_bf16_f32 v60, v44, v45
    v_exp_f32 v47, v47
    v_exp_f32 v48, v48
    v_cvt_pk_bf16_f32 v61, v46, v47
    v_exp_f32 v49, v49
    v_exp_f32 v50, v50
    v_mfma_f32_32x32x16_bf16 v[28:43], v[84:87], v[116:119], v[12:27]
    v_cvt_pk_bf16_f32 v62, v48, v49
    v_exp_f32 v51, v51
    v_exp_f32 v52, v52
    v_cvt_pk_bf16_f32 v63, v50, v51
    v_exp_f32 v53, v53
    v_exp_f32 v54, v54
    v_mfma_f32_32x32x16_bf16 v[68:83], v[88:91], v[60:63], v[68:83]
    v_cvt_pk_bf16_f32 v64, v52, v53
    v_exp_f32 v55, v55
    v_exp_f32 v56, v56
    v_cvt_pk_bf16_f32 v65, v54, v55
    v_exp_f32 v57, v57
    v_exp_f32 v58, v58
    v_exp_f32 v59, v59
    v_cvt_pk_bf16_f32 v66, v56, v57
    v_cvt_pk_bf16_f32 v67, v58, v59
    s_setprio 0
    ds_read_b128 v[92:95], v97 offset:6656
    ds_read_b128 v[84:87], v96 offset:18432
    ds_read_b128 v[88:91], v98 offset:0
    s_bitcmp1_b32 s98, s57
    s_cselect_b64 exec, -1, 0
    s_cselect_b32 s40, 1024, 0
    s_mov_b32 m0, s26
    s_add_u32 s26, s26, s40
    s_lshl_b32 s40, s40, 3
    buffer_load_dwordx4 v126, s[68:71], s27 offen lds
    s_add_u32 s27, s27, s40
    s_mov_b64 exec, -1
    s_waitcnt lgkmcnt(0)
    v_exp_f32 v28, v28
    v_exp_f32 v29, v29
    v_mfma_f32_32x32x16_bf16 v[68:83], v[92:95], v[64:67], v[68:83]
    s_setprio 1
    v_exp_f32 v30, v30
    v_cvt_pk_bf16_f32 v60, v28, v29
    v_exp_f32 v31, v31
    v_exp_f32 v32, v32
    v_cvt_pk_bf16_f32 v61, v30, v31
    v_exp_f32 v33, v33
    v_exp_f32 v34, v34
    v_mfma_f32_32x32x16_bf16 v[44:59], v[84:87], v[116:119], v[12:27]
    v_cvt_pk_bf16_f32 v62, v32, v33
    v_exp_f32 v35, v35
    v_exp_f32 v36, v36
    v_cvt_pk_bf16_f32 v63, v34, v35
    v_exp_f32 v37, v37
    v_exp_f32 v38, v38
    v_mfma_f32_32x32x16_bf16 v[68:83], v[88:91], v[60:63], v[68:83]
    v_cvt_pk_bf16_f32 v64, v36, v37
    v_exp_f32 v39, v39
    v_exp_f32 v40, v40
    v_cvt_pk_bf16_f32 v65, v38, v39
    v_exp_f32 v41, v41
    v_exp_f32 v42, v42
    v_exp_f32 v43, v43
    v_cvt_pk_bf16_f32 v66, v40, v41
    v_cvt_pk_bf16_f32 v67, v42, v43
    s_setprio 0
    ds_read_b128 v[92:95], v98 offset:512
    ds_read_b128 v[84:87], v96 offset:20480
    ds_read_b128 v[88:91], v98 offset:2048
    s_add_u32 m0, s39, 49152
    s_nop 0
    buffer_load_dwordx4 v101, s[8:11], s35 offen offset:1024 sc1 lds
    s_add_u32 s35, s35, 8192
    s_cmp_eq_u32 s35, s36
    s_cselect_b32 s35, s37, s35
    s_waitcnt lgkmcnt(0)
    v_exp_f32 v44, v44
    v_exp_f32 v45, v45
    v_mfma_f32_32x32x16_bf16 v[68:83], v[92:95], v[64:67], v[68:83]
    s_setprio 1
    v_exp_f32 v46, v46
    v_cvt_pk_bf16_f32 v60, v44, v45
    v_exp_f32 v47, v47
    v_exp_f32 v48, v48
    v_cvt_pk_bf16_f32 v61, v46, v47
    v_exp_f32 v49, v49
    v_exp_f32 v50, v50
    v_mfma_f32_32x32x16_bf16 v[28:43], v[84:87], v[116:119], v[12:27]
    v_cvt_pk_bf16_f32 v62, v48, v49
    v_exp_f32 v51, v51
    v_exp_f32 v52, v52
    v_cvt_pk_bf16_f32 v63, v50, v51
    v_exp_f32 v53, v53
    v_exp_f32 v54, v54
    v_mfma_f32_32x32x16_bf16 v[68:83], v[88:91], v[60:63], v[68:83]
    v_cvt_pk_bf16_f32 v64, v52, v53
    v_exp_f32 v55, v55
    v_exp_f32 v56, v56
    v_cvt_pk_bf16_f32 v65, v54, v55
    v_exp_f32 v57, v57
    v_exp_f32 v58, v58
    v_exp_f32 v59, v59
    v_cvt_pk_bf16_f32 v66, v56, v57
    v_cvt_pk_bf16_f32 v67, v58, v59
    s_setprio 0
    ds_read_b128 v[92:95], v98 offset:2560
    ds_read_b128 v[84:87], v96 offset:22528
    ds_read_b128 v[88:91], v98 offset:4096
    s_bitcmp1_b32 s93, s57
    s_cselect_b64 exec, 0xffff, 0
    buffer_load_dwordx2 v[6:7], v8, s[8:11], s97 offen sc1
    s_mov_b64 exec, -1
    s_waitcnt lgkmcnt(0)
    v_exp_f32 v28, v28
    v_exp_f32 v29, v29
    v_mfma_f32_32x32x16_bf16 v[68:83], v[92:95], v[64:67], v[68:83]
    s_setprio 1
    v_exp_f32 v30, v30
    v_cvt_pk_bf16_f32 v60, v28, v29
    v_exp_f32 v31, v31
    v_exp_f32 v32, v32
    v_cvt_pk_bf16_f32 v61, v30, v31
    v_exp_f32 v33, v33
    v_exp_f32 v34, v34
    v_mfma_f32_32x32x16_bf16 v[44:59], v[84:87], v[116:119], v[12:27]
    v_cvt_pk_bf16_f32 v62, v32, v33
    v_exp_f32 v35, v35
    v_exp_f32 v36, v36
    v_cvt_pk_bf16_f32 v63, v34, v35
    v_exp_f32 v37, v37
    v_exp_f32 v38, v38
    v_mfma_f32_32x32x16_bf16 v[68:83], v[88:91], v[60:63], v[68:83]
    v_cvt_pk_bf16_f32 v64, v36, v37
    v_exp_f32 v39, v39
    v_exp_f32 v40, v40
    v_cvt_pk_bf16_f32 v65, v38, v39
    v_exp_f32 v41, v41
    v_exp_f32 v42, v42
    v_exp_f32 v43, v43
    v_cvt_pk_bf16_f32 v66, v40, v41
    v_cvt_pk_bf16_f32 v67, v42, v43
    s_setprio 0
    s_waitcnt vmcnt(2)
    s_barrier
    ds_read_b128 v[92:95], v98 offset:4608
    ds_read_b128 v[84:87], v96 offset:32768
    ds_read_b128 v[88:91], v98 offset:6144
    s_add_u32 m0, s39, 0
    s_nop 0
    buffer_load_dwordx4 v101, s[8:11], s35 offen sc1 lds
    s_waitcnt lgkmcnt(0)
    v_exp_f32 v44, v44
    v_exp_f32 v45, v45
    v_mfma_f32_32x32x16_bf16 v[68:83], v[92:95], v[64:67], v[68:83]
    s_setprio 1
    v_exp_f32 v46, v46
    v_cvt_pk_bf16_f32 v60, v44, v45
    v_exp_f32 v47, v47
    v_exp_f32 v48, v48
    v_cvt_pk_bf16_f32 v61, v46, v47
    v_exp_f32 v49, v49
    v_exp_f32 v50, v50
    v_mfma_f32_32x32x16_bf16 v[28:43], v[84:87], v[116:119], v[12:27]
    v_cvt_pk_bf16_f32 v62, v48, v49
    v_exp_f32 v51, v51
    v_exp_f32 v52, v52
    v_cvt_pk_bf16_f32 v63, v50, v51
    v_exp_f32 v53, v53
    v_exp_f32 v54, v54
    v_mfma_f32_32x32x16_bf16 v[68:83], v[88:91], v[60:63], v[68:83]
    v_cvt_pk_bf16_f32 v64, v52, v53
    v_exp_f32 v55, v55
    v_exp_f32 v56, v56
    v_cvt_pk_bf16_f32 v65, v54, v55
    v_exp_f32 v57, v57
    v_exp_f32 v58, v58
    v_exp_f32 v59, v59
    v_cvt_pk_bf16_f32 v66, v56, v57
    v_cvt_pk_bf16_f32 v67, v58, v59
    s_setprio 0
    ds_read_b128 v[92:95], v98 offset:6656
    ds_read_b128 v[84:87], v96 offset:34816
    ds_read_b128 v[88:91], v99 offset:0
    s_bitcmp1_b32 s98, s57
    s_cselect_b64 exec, -1, 0
    s_cselect_b32 s40, 1024, 0
    s_mov_b32 m0, s26
    s_add_u32 s26, s26, s40
    s_lshl_b32 s40, s40, 3
    buffer_load_dwordx4 v126, s[68:71], s27 offen lds
    s_add_u32 s27, s27, s40
    s_mov_b64 exec, -1
    s_waitcnt lgkmcnt(0)
    v_exp_f32 v28, v28
    v_exp_f32 v29, v29
    v_mfma_f32_32x32x16_bf16 v[68:83], v[92:95], v[64:67], v[68:83]
    s_setprio 1
    v_exp_f32 v30, v30
    v_cvt_pk_bf16_f32 v60, v28, v29
    v_exp_f32 v31, v31
    v_exp_f32 v32, v32
    v_cvt_pk_bf16_f32 v61, v30, v31
    v_exp_f32 v33, v33
    v_exp_f32 v34, v34
    v_mfma_f32_32x32x16_bf16 v[44:59], v[84:87], v[116:119], v[12:27]
    v_cvt_pk_bf16_f32 v62, v32, v33
    v_exp_f32 v35, v35
    v_exp_f32 v36, v36
    v_cvt_pk_bf16_f32 v63, v34, v35
    v_exp_f32 v37, v37
    v_exp_f32 v38, v38
    v_mfma_f32_32x32x16_bf16 v[68:83], v[88:91], v[60:63], v[68:83]
    v_cvt_pk_bf16_f32 v64, v36, v37
    v_exp_f32 v39, v39
    v_exp_f32 v40, v40
    v_cvt_pk_bf16_f32 v65, v38, v39
    v_exp_f32 v41, v41
    v_exp_f32 v42, v42
    v_exp_f32 v43, v43
    v_cvt_pk_bf16_f32 v66, v40, v41
    v_cvt_pk_bf16_f32 v67, v42, v43
    s_setprio 0
    ds_read_b128 v[92:95], v99 offset:512
    ds_read_b128 v[84:87], v96 offset:36864
    ds_read_b128 v[88:91], v99 offset:2048
    s_add_u32 m0, s39, 0
    s_nop 0
    buffer_load_dwordx4 v101, s[8:11], s35 offen offset:1024 sc1 lds
    s_add_u32 s35, s35, 8192
    s_cmp_eq_u32 s35, s36
    s_cselect_b32 s35, s37, s35
    s_waitcnt lgkmcnt(0)
    v_exp_f32 v44, v44
    v_exp_f32 v45, v45
    v_mfma_f32_32x32x16_bf16 v[68:83], v[92:95], v[64:67], v[68:83]
    s_setprio 1
    v_exp_f32 v46, v46
    v_cvt_pk_bf16_f32 v60, v44, v45
    v_exp_f32 v47, v47
    v_exp_f32 v48, v48
    v_cvt_pk_bf16_f32 v61, v46, v47
    v_exp_f32 v49, v49
    v_exp_f32 v50, v50
    v_mfma_f32_32x32x16_bf16 v[28:43], v[84:87], v[116:119], v[12:27]
    v_cvt_pk_bf16_f32 v62, v48, v49
    v_exp_f32 v51, v51
    v_exp_f32 v52, v52
    v_cvt_pk_bf16_f32 v63, v50, v51
    v_exp_f32 v53, v53
    v_exp_f32 v54, v54
    v_mfma_f32_32x32x16_bf16 v[68:83], v[88:91], v[60:63], v[68:83]
    v_cvt_pk_bf16_f32 v64, v52, v53
    v_exp_f32 v55, v55
    v_exp_f32 v56, v56
    v_cvt_pk_bf16_f32 v65, v54, v55
    v_exp_f32 v57, v57
    v_exp_f32 v58, v58
    v_exp_f32 v59, v59
    v_cvt_pk_bf16_f32 v66, v56, v57
    v_cvt_pk_bf16_f32 v67, v58, v59
    s_setprio 0
    ds_read_b128 v[92:95], v99 offset:2560
    ds_read_b128 v[84:87], v96 offset:38912
    ds_read_b128 v[88:91], v99 offset:4096
    s_bitcmp1_b32 s92, s57
    s_cselect_b64 exec, 1, 0
    buffer_store_dwordx2 v[10:11], off, s[8:11], s96 sc1
    s_mov_b64 exec, -1
    s_waitcnt lgkmcnt(0)
    v_exp_f32 v28, v28
    v_exp_f32 v29, v29
    v_mfma_f32_32x32x16_bf16 v[68:83], v[92:95], v[64:67], v[68:83]
    s_setprio 1
    v_exp_f32 v30, v30
    v_cvt_pk_bf16_f32 v60, v28, v29
    v_exp_f32 v31, v31
    v_exp_f32 v32, v32
    v_cvt_pk_bf16_f32 v61, v30, v31
    v_exp_f32 v33, v33
    v_exp_f32 v34, v34
    v_mfma_f32_32x32x16_bf16 v[44:59], v[84:87], v[116:119], v[12:27]
    v_cvt_pk_bf16_f32 v62, v32, v33
    v_exp_f32 v35, v35
    v_exp_f32 v36, v36
    v_cvt_pk_bf16_f32 v63, v34, v35
    v_exp_f32 v37, v37
    v_exp_f32 v38, v38
    v_mfma_f32_32x32x16_bf16 v[68:83], v[88:91], v[60:63], v[68:83]
    v_cvt_pk_bf16_f32 v64, v36, v37
    v_exp_f32 v39, v39
    v_exp_f32 v40, v40
    v_cvt_pk_bf16_f32 v65, v38, v39
    v_exp_f32 v41, v41
    v_exp_f32 v42, v42
    v_exp_f32 v43, v43
    v_cvt_pk_bf16_f32 v66, v40, v41
    v_cvt_pk_bf16_f32 v67, v42, v43
    s_setprio 0
    s_waitcnt vmcnt(2)
    s_barrier
    ds_read_b128 v[92:95], v99 offset:4608
    ds_read_b128 v[84:87], v96 offset:49152
    ds_read_b128 v[88:91], v99 offset:6144
    s_add_u32 m0, s39, 16384
    s_nop 0
    buffer_load_dwordx4 v101, s[8:11], s35 offen sc1 lds
    s_waitcnt lgkmcnt(0)
    v_exp_f32 v44, v44
    v_exp_f32 v45, v45
    v_mfma_f32_32x32x16_bf16 v[68:83], v[92:95], v[64:67], v[68:83]
    s_setprio 1
    v_exp_f32 v46, v46
    v_cvt_pk_bf16_f32 v60, v44, v45
    v_exp_f32 v47, v47
    v_exp_f32 v48, v48
    v_cvt_pk_bf16_f32 v61, v46, v47
    v_exp_f32 v49, v49
    v_exp_f32 v50, v50
    v_mfma_f32_32x32x16_bf16 v[28:43], v[84:87], v[116:119], v[12:27]
    v_cvt_pk_bf16_f32 v62, v48, v49
    v_exp_f32 v51, v51
    v_exp_f32 v52, v52
    v_cvt_pk_bf16_f32 v63, v50, v51
    v_exp_f32 v53, v53
    v_exp_f32 v54, v54
    v_mfma_f32_32x32x16_bf16 v[68:83], v[88:91], v[60:63], v[68:83]
    v_cvt_pk_bf16_f32 v64, v52, v53
    v_exp_f32 v55, v55
    v_exp_f32 v56, v56
    v_cvt_pk_bf16_f32 v65, v54, v55
    v_exp_f32 v57, v57
    v_exp_f32 v58, v58
    v_exp_f32 v59, v59
    v_cvt_pk_bf16_f32 v66, v56, v57
    v_cvt_pk_bf16_f32 v67, v58, v59
    s_setprio 0
    ds_read_b128 v[92:95], v99 offset:6656
    ds_read_b128 v[84:87], v96 offset:51200
    ds_read_b128 v[88:91], v100 offset:0
    s_bitcmp1_b32 s99, s57
    s_cselect_b64 exec, -1, 0
    s_cselect_b32 s40, 1024, 0
    s_mov_b32 m0, s26
    s_add_u32 s26, s26, s40
    s_lshl_b32 s40, s40, 3
    buffer_load_dwordx4 v126, s[68:71], s27 offen lds
    s_add_u32 s27, s27, s40
    s_mov_b64 exec, -1
    s_waitcnt lgkmcnt(0)
    v_exp_f32 v28, v28
    v_exp_f32 v29, v29
    v_mfma_f32_32x32x16_bf16 v[68:83], v[92:95], v[64:67], v[68:83]
    s_setprio 1
    v_exp_f32 v30, v30
    v_cvt_pk_bf16_f32 v60, v28, v29
    v_exp_f32 v31, v31
    v_exp_f32 v32, v32
    v_cvt_pk_bf16_f32 v61, v30, v31
    v_exp_f32 v33, v33
    v_exp_f32 v34, v34
    v_mfma_f32_32x32x16_bf16 v[44:59], v[84:87], v[116:119], v[12:27]
    v_cvt_pk_bf16_f32 v62, v32, v33
    v_exp_f32 v35, v35
    v_exp_f32 v36, v36
    v_cvt_pk_bf16_f32 v63, v34, v35
    v_exp_f32 v37, v37
    v_exp_f32 v38, v38
    v_mfma_f32_32x32x16_bf16 v[68:83], v[88:91], v[60:63], v[68:83]
    v_cvt_pk_bf16_f32 v64, v36, v37
    v_exp_f32 v39, v39
    v_exp_f32 v40, v40
    v_cvt_pk_bf16_f32 v65, v38, v39
    v_exp_f32 v41, v41
    v_exp_f32 v42, v42
    v_exp_f32 v43, v43
    v_cvt_pk_bf16_f32 v66, v40, v41
    v_cvt_pk_bf16_f32 v67, v42, v43
    s_setprio 0
    ds_read_b128 v[92:95], v100 offset:512
    ds_read_b128 v[84:87], v96 offset:53248
    ds_read_b128 v[88:91], v100 offset:2048
    s_add_u32 m0, s39, 16384
    s_nop 0
    buffer_load_dwordx4 v101, s[8:11], s35 offen offset:1024 sc1 lds
    s_add_u32 s35, s35, 8192
    s_cmp_eq_u32 s35, s36
    s_cselect_b32 s35, s37, s35
    s_waitcnt lgkmcnt(0)
    v_exp_f32 v44, v44
    v_exp_f32 v45, v45
    v_mfma_f32_32x32x16_bf16 v[68:83], v[92:95], v[64:67], v[68:83]
    s_setprio 1
    v_exp_f32 v46, v46
    v_cvt_pk_bf16_f32 v60, v44, v45
    v_exp_f32 v47, v47
    v_exp_f32 v48, v48
    v_cvt_pk_bf16_f32 v61, v46, v47
    v_exp_f32 v49, v49
    v_exp_f32 v50, v50
    v_mfma_f32_32x32x16_bf16 v[28:43], v[84:87], v[116:119], v[12:27]
    v_cvt_pk_bf16_f32 v62, v48, v49
    v_exp_f32 v51, v51
    v_exp_f32 v52, v52
    v_cvt_pk_bf16_f32 v63, v50, v51
    v_exp_f32 v53, v53
    v_exp_f32 v54, v54
    v_mfma_f32_32x32x16_bf16 v[68:83], v[88:91], v[60:63], v[68:83]
    v_cmp_ne_u64 vcc, s[52:53], v[6:7]
    v_cvt_pk_bf16_f32 v64, v52, v53
    v_exp_f32 v55, v55
    v_exp_f32 v56, v56
    v_cvt_pk_bf16_f32 v65, v54, v55
    v_exp_f32 v57, v57
    v_exp_f32 v58, v58
    v_exp_f32 v59, v59
    v_cvt_pk_bf16_f32 v66, v56, v57
    v_cvt_pk_bf16_f32 v67, v58, v59
    s_setprio 0
    ds_read_b128 v[92:95], v100 offset:2560
    ds_read_b128 v[84:87], v96 offset:55296
    ds_read_b128 v[88:91], v100 offset:4096
    s_waitcnt lgkmcnt(0)
    v_exp_f32 v28, v28
    v_exp_f32 v29, v29
    v_mfma_f32_32x32x16_bf16 v[68:83], v[92:95], v[64:67], v[68:83]
    s_setprio 1
    v_exp_f32 v30, v30
    v_cvt_pk_bf16_f32 v60, v28, v29
    v_exp_f32 v31, v31
    v_exp_f32 v32, v32
    v_cvt_pk_bf16_f32 v61, v30, v31
    v_exp_f32 v33, v33
    v_exp_f32 v34, v34
    v_mfma_f32_32x32x16_bf16 v[44:59], v[84:87], v[116:119], v[12:27]
    v_cvt_pk_bf16_f32 v62, v32, v33
    v_exp_f32 v35, v35
    v_exp_f32 v36, v36
    v_cvt_pk_bf16_f32 v63, v34, v35
    v_exp_f32 v37, v37
    v_exp_f32 v38, v38
    v_mfma_f32_32x32x16_bf16 v[68:83], v[88:91], v[60:63], v[68:83]
    v_cvt_pk_bf16_f32 v64, v36, v37
    v_exp_f32 v39, v39
    v_exp_f32 v40, v40
    v_cvt_pk_bf16_f32 v65, v38, v39
    v_exp_f32 v41, v41
    v_exp_f32 v42, v42
    v_exp_f32 v43, v43
    v_cvt_pk_bf16_f32 v66, v40, v41
    v_cvt_pk_bf16_f32 v67, v42, v43
    s_setprio 0
    s_waitcnt vmcnt(2)
    s_barrier
    ds_read_b128 v[92:95], v100 offset:4608
    ds_read_b128 v[84:87], v96 offset:0
    ds_read_b128 v[88:91], v100 offset:6144
    s_add_u32 m0, s39, 32768
    s_nop 0
    buffer_load_dwordx4 v101, s[8:11], s35 offen sc1 lds
    s_waitcnt lgkmcnt(0)
    v_exp_f32 v44, v44
    v_exp_f32 v45, v45
    v_mfma_f32_32x32x16_bf16 v[68:83], v[92:95], v[64:67], v[68:83]
    s_setprio 1
    v_exp_f32 v46, v46
    v_cvt_pk_bf16_f32 v60, v44, v45
    v_exp_f32 v47, v47
    v_exp_f32 v48, v48
    v_cvt_pk_bf16_f32 v61, v46, v47
    v_exp_f32 v49, v49
    v_exp_f32 v50, v50
    v_mfma_f32_32x32x16_bf16 v[28:43], v[84:87], v[116:119], v[12:27]
    v_cvt_pk_bf16_f32 v62, v48, v49
    v_exp_f32 v51, v51
    v_exp_f32 v52, v52
    v_cvt_pk_bf16_f32 v63, v50, v51
    v_exp_f32 v53, v53
    v_exp_f32 v54, v54
    v_mfma_f32_32x32x16_bf16 v[68:83], v[88:91], v[60:63], v[68:83]
    v_cvt_pk_bf16_f32 v64, v52, v53
    v_exp_f32 v55, v55
    v_exp_f32 v56, v56
    v_cvt_pk_bf16_f32 v65, v54, v55
    v_exp_f32 v57, v57
    v_exp_f32 v58, v58
    v_exp_f32 v59, v59
    v_cvt_pk_bf16_f32 v66, v56, v57
    v_cvt_pk_bf16_f32 v67, v58, v59
    s_setprio 0
    ds_read_b128 v[92:95], v100 offset:6656
    ds_read_b128 v[84:87], v96 offset:2048
    ds_read_b128 v[88:91], v97 offset:0
    s_add_u32 s57, s57, 1
    s_bitcmp1_b32 s58, s57
    s_cselect_b32 s40, 1, 0
    s_or_b32 s40, s40, vcc_lo
    s_cbranch_scc0 L_loop_X
    s_cmp_eq_u32 s57, 4
    s_cbranch_scc0 L_sp_X
    ds_read_b128 v[44:47], v96 offset:0
    s_waitcnt lgkmcnt(1)
    v_mfma_f32_32x32x16_bf16 v[68:83], v[92:95], v[64:67], v[68:83]
    s_waitcnt lgkmcnt(0)
    v_mfma_f32_32x32x16_bf16 v[28:43], v[44:47], v[120:123], 0
    s_nop 7
    s_nop 4
    v_mov_b32 v112, v76
    v_mov_b32 v113, v76
    v_max3_f32 v106, abs(v68), abs(v69), abs(v70)
    v_max3_f32 v107, abs(v71), abs(v72), abs(v73)
    v_permlane32_swap_b32 v112, v113
    v_max3_f32 v106, v106, abs(v74), abs(v75)
    v_mov_b32 v108, 0x79000000
    v_max_f32 v106, v106, v107
    v_cmp_nle_f32 s[42:43], v112, v108
    v_mul_f32 v107, 0x3b800000, v106
    v_cmp_nle_f32 vcc, v107, v108
    v_rcp_f32 v106, v112
    s_nop 3
    s_or_b64 vcc, vcc, s[42:43]
    s_cbranch_vccnz L_slow
L_normB_X:
    v_mul_f32 v106, v106, v102
    v_mul_f32 v68, v68, v106
    v_mul_f32 v69, v69, v106
    v_mul_f32 v70, v70, v106
    v_mul_f32 v71, v71, v106
    v_mul_f32 v72, v72, v106
    v_mul_f32 v73, v73, v106
    v_mul_f32 v74, v74, v106
    v_mul_f32 v75, v75, v106
    v_cvt_pk_bf16_f32 v60, v68, v69
    v_cvt_pk_bf16_f32 v61, v70, v71
    v_cvt_pk_bf16_f32 v62, v72, v73
    v_cvt_pk_bf16_f32 v63, v74, v75
    buffer_store_dwordx4 v[60:63], v104, s[8:11], s50 offen sc1
    v_mov_b32 v64, 0
    v_mov_b32 v65, 0
    v_mov_b32 v66, 0
    v_mov_b32 v67, 0
    v_max3_f32 v106, v28, v29, v30
    v_max3_f32 v107, v31, v32, v33
    v_max3_f32 v108, v34, v35, v36
    v_max3_f32 v109, v37, v38, v39
    v_max3_f32 v106, v106, v40, v41
    v_max3_f32 v107, v107, v42, v43
    v_max3_f32 v106, v106, v108, v109
    v_mfma_f32_32x32x16_bf16 v[68:83], v[92:95], v[64:67], 0
    v_max_f32 v106, v106, v107
    s_nop 0
    v_mov_b32 v107, v106
    s_nop 1
    v_permlane32_swap_b32 v106, v107
    s_nop 0
    v_max_f32 v106, v106, v107
    v_add_f32 v106, 0x42c80000, v106
    v_sub_f32 v12, 0, v106
    v_sub_f32 v13, 0, v106
    v_sub_f32 v14, 0, v106
    v_sub_f32 v15, 0, v106
    v_sub_f32 v16, 0, v106
    v_sub_f32 v17, 0, v106
    v_sub_f32 v18, 0, v106
    v_sub_f32 v19, 0, v106
    v_sub_f32 v20, 0, v106
    v_sub_f32 v21, 0, v106
    v_sub_f32 v22, 0, v106
    v_sub_f32 v23, 0, v106
    v_sub_f32 v24, 0, v106
    v_sub_f32 v25, 0, v106
    v_sub_f32 v26, 0, v106
    v_sub_f32 v27, 0, v106
    s_nop 1
    v_mfma_f32_32x32x16_bf16 v[28:43], v[44:47], v[120:123], v[12:27]
    v_mov_b32 v116, v120
    v_mov_b32 v117, v121
    v_mov_b32 v118, v122
    v_mov_b32 v119, v123
    v_mov_b32 v102, v103
    s_add_u32 s50, s50, 2097152
    s_mov_b32 s51, s37
    s_mov_b32 s49, 1
    s_mov_b32 s12, s76
    s_mov_b32 s13, s77
    s_mov_b32 s14, s78
    s_mov_b32 s15, s79
    s_lshl_b32 s96, s28, 7
    s_lshl_b32 s41, s29, 3
    s_add_u32 s96, s96, s41
    s_add_u32 s96, s96, 15736832
    s_lshr_b32 s97, s66, 1
    s_lshl_b32 s97, s97, 7
    s_add_u32 s97, s97, 15736832
    s_mov_b64 vcc, 0
    s_branch L_loop_X
L_redoT_X:
    ds_read_b128 v[44:47], v96 offset:0
    ds_read_b128 v[84:87], v96 offset:2048
    s_waitcnt lgkmcnt(0)
    v_mfma_f32_32x32x16_bf16 v[28:43], v[44:47], v[120:123], 0
    s_nop 7
    s_nop 7
    s_branch L_normB_X
L_sp_X:
    s_cmp_eq_u32 s57, 8
    s_cbranch_scc0 L_fix
    s_waitcnt lgkmcnt(0)
    v_mfma_f32_32x32x16_bf16 v[68:83], v[92:95], v[64:67], v[68:83]
    s_nop 7
    s_nop 7
    v_mov_b32 v112, v76
    v_mov_b32 v113, v76
    v_max3_f32 v106, abs(v68), abs(v69), abs(v70)
    v_max3_f32 v107, abs(v71), abs(v72), abs(v73)
    v_permlane32_swap_b32 v112, v113
    v_max3_f32 v106, v106, abs(v74), abs(v75)
    v_mov_b32 v108, 0x79000000
    v_max_f32 v106, v106, v107
    v_cmp_nle_f32 s[42:43], v112, v108
    v_mul_f32 v107, 0x3b800000, v106
    v_cmp_nle_f32 vcc, v107, v108
    v_rcp_f32 v106, v112
    s_nop 3
    s_or_b64 vcc, vcc, s[42:43]
    s_cbranch_vccnz L_slow
L_normA_X:
    v_mul_f32 v106, v106, v102
    v_mul_f32 v68, v68, v106
    v_mul_f32 v69, v69, v106
    v_mul_f32 v70, v70, v106
    v_mul_f32 v71, v71, v106
    v_mul_f32 v72, v72, v106
    v_mul_f32 v73, v73, v106
    v_mul_f32 v74, v74, v106
    v_mul_f32 v75, v75, v106
    v_cvt_pk_bf16_f32 v60, v68, v69
    v_cvt_pk_bf16_f32 v61, v70, v71
    v_cvt_pk_bf16_f32 v62, v72, v73
    v_cvt_pk_bf16_f32 v63, v74, v75
    buffer_store_dwordx4 v[60:63], v104, s[8:11], s50 offen sc1
    s_branch L_attn_done
L_fix:
    s_mov_b32 s59, 131072
    v_lshlrev_b32 v110, 4, v1
    s_mov_b32 s46, s97
    s_mov_b64 exec, 255
L_pollfix:
    buffer_load_dwordx4 v[106:109], v110, s[8:11], s46 offen sc1
    s_waitcnt vmcnt(0)
    v_xor_b32 v106, s52, v106
    v_xor_b32 v107, s53, v107
    v_xor_b32 v108, s52, v108
    v_xor_b32 v109, s53, v109
    v_or3_b32 v106, v106, v107, v108
    v_or_b32 v106, v106, v109
    v_cmp_ne_u32 vcc, 0, v106
    s_nop 4
    s_cbranch_vccz L_pollfix_ok
    s_sub_u32 s59, s59, 1
    s_cmp_eq_u32 s59, 0
    s_cbranch_scc1 L_pollfix_ok
    s_sleep 1
    s_branch L_pollfix
L_pollfix_ok:
    s_mov_b64 exec, -1
    v_mov_b32 v6, s52
    v_mov_b32 v7, s53
    s_mov_b64 vcc, 0
    s_branch L_loop_X
L_task_Y:
    ds_read_b128 v[44:47], v96 offset:0
    ds_read_b128 v[84:87], v96 offset:2048
    ds_read_b128 v[88:91], v97 offset:0
    v_mov_b32 v92, 0
    v_mov_b32 v93, 0
    v_mov_b32 v94, 0
    v_mov_b32 v95, 0
    s_waitcnt lgkmcnt(2)
    v_mfma_f32_32x32x16_bf16 v[28:43], v[44:47], v[116:119], 0
    s_nop 7
    s_nop 7
    v_mov_b32 v64, 0
    v_mov_b32 v65, 0
    v_mov_b32 v66, 0
    v_mov_b32 v67, 0
    v_max3_f32 v106, v28, v29, v30
    v_max3_f32 v107, v31, v32, v33
    v_max3_f32 v108, v34, v35, v36
    v_max3_f32 v109, v37, v38, v39
    v_max3_f32 v106, v106, v40, v41
    v_max3_f32 v107, v107, v42, v43
    v_max3_f32 v106, v106, v108, v109
    v_mfma_f32_32x32x16_bf16 v[68:83], v[92:95], v[64:67], 0
    v_max_f32 v106, v106, v107
    s_nop 0
    v_mov_b32 v107, v106
    s_nop 1
    v_permlane32_swap_b32 v106, v107
    s_nop 0
    v_max_f32 v106, v106, v107
    v_add_f32 v106, 0x42c80000, v106
    v_sub_f32 v12, 0, v106
    v_sub_f32 v13, 0, v106
    v_sub_f32 v14, 0, v106
    v_sub_f32 v15, 0, v106
    v_sub_f32 v16, 0, v106
    v_sub_f32 v17, 0, v106
    v_sub_f32 v18, 0, v106
    v_sub_f32 v19, 0, v106
    v_sub_f32 v20, 0, v106
    v_sub_f32 v21, 0, v106
    v_sub_f32 v22, 0, v106
    v_sub_f32 v23, 0, v106
    v_sub_f32 v24, 0, v106
    v_sub_f32 v25, 0, v106
    v_sub_f32 v26, 0, v106
    v_sub_f32 v27, 0, v106
    s_nop 1
    v_mfma_f32_32x32x16_bf16 v[28:43], v[44:47], v[116:119], v[12:27]
    s_nop 7
    s_nop 3
.p2align 6
L_loop_Y:
    s_waitcnt lgkmcnt(0)
    v_exp_f32 v28, v28
    v_exp_f32 v29, v29
    v_mfma_f32_32x32x16_bf16 v[68:83], v[92:95], v[64:67], v[68:83]
    s_setprio 1
    v_exp_f32 v30, v30
    v_cvt_pk_bf16_f32 v60, v28, v29
    v_exp_f32 v31, v31
    v_exp_f32 v32, v32
    v_cvt_pk_bf16_f32 v61, v30, v31
    v_exp_f32 v33, v33
    v_exp_f32 v34, v34
    v_mfma_f32_32x32x16_bf16 v[44:59], v[84:87], v[116:119], v[12:27]
    v_cvt_pk_bf16_f32 v62, v32, v33
    v_exp_f32 v35, v35
    v_exp_f32 v36, v36
    v_cvt_pk_bf16_f32 v63, v34, v35
    v_exp_f32 v37, v37
    v_exp_f32 v38, v38
    v_mfma_f32_32x32x16_bf16 v[68:83], v[88:91], v[60:63], v[68:83]
    v_cvt_pk_bf16_f32 v64, v36, v37
    v_exp_f32 v39, v39
    v_exp_f32 v40, v40
    v_cvt_pk_bf16_f32 v65, v38, v39
    v_exp_f32 v41, v41
    v_exp_f32 v42, v42
    v_exp_f32 v43, v43
    v_cvt_pk_bf16_f32 v66, v40, v41
    v_cvt_pk_bf16_f32 v67, v42, v43
    s_setprio 0
    ds_read_b128 v[92:95], v97 offset:512
    ds_read_b128 v[84:87], v96 offset:4096
    ds_read_b128 v[88:91], v97 offset:2048
    s_add_u32 m0, s39, 32768
    s_nop 0
    buffer_load_dwordx4 v101, s[8:11], s35 offen offset:1024 sc1 lds
    s_add_u32 s35, s35, 8192
    s_cmp_eq_u32 s35, s36
    s_cselect_b32 s35, s37, s35
    s_waitcnt lgkmcnt(0)
    v_exp_f32 v44, v44
    v_exp_f32 v45, v45
    v_mfma_f32_32x32x16_bf16 v[68:83], v[92:95], v[64:67], v[68:83]
    s_setprio 1
    v_exp_f32 v46, v46
    v_cvt_pk_bf16_f32 v60, v44, v45
    v_exp_f32 v47, v47
    v_exp_f32 v48, v48
    v_cvt_pk_bf16_f32 v61, v46, v47
    v_exp_f32 v49, v49
    v_exp_f32 v50, v50
    v_mfma_f32_32x32x16_bf16 v[28:43], v[84:87], v[116:119], v[12:27]
    v_cvt_pk_bf16_f32 v62, v48, v49
    v_exp_f32 v51, v51
    v_exp_f32 v52, v52
    v_cvt_pk_bf16_f32 v63, v50, v51
    v_exp_f32 v53, v53
    v_exp_f32 v54, v54
    v_mfma_f32_32x32x16_bf16 v[68:83], v[88:91], v[60:63], v[68:83]
    v_cvt_pk_bf16_f32 v64, v52, v53
    v_exp_f32 v55, v55
    v_exp_f32 v56, v56
    v_cvt_pk_bf16_f32 v65, v54, v55
    v_exp_f32 v57, v57
    v_exp_f32 v58, v58
    v_exp_f32 v59, v59
    v_cvt_pk_bf16_f32 v66, v56, v57
    v_cvt_pk_bf16_f32 v67, v58, v59
    s_setprio 0
    ds_read_b128 v[92:95], v97 offset:2560
    ds_read_b128 v[84:87], v96 offset:6144
    ds_read_b128 v[88:91], v97 offset:4096
    s_waitcnt vmcnt(2) lgkmcnt(0)
    s_barrier
    v_exp_f32 v28, v28
    v_exp_f32 v29, v29
    v_mfma_f32_32x32x16_bf16 v[68:83], v[92:95], v[64:67], v[68:83]
    s_setprio 1
    v_exp_f32 v30, v30
    v_cvt_pk_bf16_f32 v60, v28, v29
    v_exp_f32 v31, v31
    v_exp_f32 v32, v32
    v_cvt_pk_bf16_f32 v61, v30, v31
    v_exp_f32 v33, v33
    v_exp_f32 v34, v34
    v_mfma_f32_32x32x16_bf16 v[44:59], v[84:87], v[116:119], v[12:27]
    v_cvt_pk_bf16_f32 v62, v32, v33
    v_exp_f32 v35, v35
    v_exp_f32 v36, v36
    v_cvt_pk_bf16_f32 v63, v34, v35
    v_exp_f32 v37, v37
    v_exp_f32 v38, v38
    v_mfma_f32_32x32x16_bf16 v[68:83], v[88:91], v[60:63], v[68:83]
    v_cvt_pk_bf16_f32 v64, v36, v37
    v_exp_f32 v39, v39
    v_exp_f32 v40, v40
    v_cvt_pk_bf16_f32 v65, v38, v39
    v_exp_f32 v41, v41
    v_exp_f32 v42, v42
    v_exp_f32 v43, v43
    v_cvt_pk_bf16_f32 v66, v40, v41
    v_cvt_pk_bf16_f32 v67, v42, v43
    s_setprio 0
    ds_read_b128 v[92:95], v97 offset:4608
    ds_read_b128 v[84:87], v96 offset:16384
    ds_read_b128 v[88:91], v97 offset:6144
    s_add_u32 m0, s39, 49152
    s_nop 0
    buffer_load_dwordx4 v101, s[8:11], s35 offen sc1 lds
    s_waitcnt lgkmcnt(0)
    v_exp_f32 v44, v44
    v_exp_f32 v45, v45
    v_mfma_f32_32x32x16_bf16 v[68:83], v[92:95], v[64:67], v[68:83]
    s_setprio 1
    v_exp_f32 v46, v46
    v_cvt_pk_bf16_f32 v60, v44, v45
    v_exp_f32 v47, v47
    v_exp_f32 v48, v48
    v_cvt_pk_bf16_f32 v61, v46, v47
    v_exp_f32 v49, v49
    v_exp_f32 v50, v50
    v_mfma_f32_32x32x16_bf16 v[28:43], v[84:87], v[116:119], v[12:27]
    v_cvt_pk_bf16_f32 v62, v48, v49
    v_exp_f32 v51, v51
    v_exp_f32 v52, v52
    v_cvt_pk_bf16_f32 v63, v50, v51
    v_exp_f32 v53, v53
    v_exp_f32 v54, v54
    v_mfma_f32_32x32x16_bf16 v[68:83], v[88:91], v[60:63], v[68:83]
    v_cvt_pk_bf16_f32 v64, v52, v53
    v_exp_f32 v55, v55
    v_exp_f32 v56, v56
    v_cvt_pk_bf16_f32 v65, v54, v55
    v_exp_f32 v57, v57
    v_exp_f32 v58, v58
    v_exp_f32 v59, v59
    v_cvt_pk_bf16_f32 v66, v56, v57
    v_cvt_pk_bf16_f32 v67, v58, v59
    s_setprio 0
    ds_read_b128 v[92:95], v97 offset:6656
    ds_read_b128 v[84:87], v96 offset:18432
    ds_read_b128 v[88:91], v98 offset:0
    s_bitcmp1_b32 s98, s57
    s_cselect_b64 exec, -1, 0
    s_cselect_b32 s40, 1024, 0
    s_mov_b32 m0, s26
    s_add_u32 s26, s26, s40
    s_lshl_b32 s40, s40, 3
    buffer_load_dwordx4 v126, s[68:71], s27 offen lds
    s_add_u32 s27, s27, s40
    s_mov_b64 exec, -1
    s_bitcmp1_b32 s89, s57
    s_cselect_b64 exec, -1, 0
    buffer_load_dword v2, v3, s[12:15], s88 offen
    s_mov_b64 exec, -1
    s_waitcnt lgkmcnt(0)
    v_exp_f32 v28, v28
    v_exp_f32 v29, v29
    v_mfma_f32_32x32x16_bf16 v[68:83], v[92:95], v[64:67], v[68:83]
    s_setprio 1
    v_exp_f32 v30, v30
    v_cvt_pk_bf16_f32 v60, v28, v29
    v_exp_f32 v31, v31
    v_exp_f32 v32, v32
    v_cvt_pk_bf16_f32 v61, v30, v31
    v_exp_f32 v33, v33
    v_exp_f32 v34, v34
    v_mfma_f32_32x32x16_bf16 v[44:59], v[84:87], v[116:119], v[12:27]
    v_cvt_pk_bf16_f32 v62, v32, v33
    v_exp_f32 v35, v35
    v_exp_f32 v36, v36
    v_cvt_pk_bf16_f32 v63, v34, v35
    v_exp_f32 v37, v37
    v_exp_f32 v38, v38
    v_mfma_f32_32x32x16_bf16 v[68:83], v[88:91], v[60:63], v[68:83]
    v_cvt_pk_bf16_f32 v64, v36, v37
    v_exp_f32 v39, v39
    v_exp_f32 v40, v40
    v_cvt_pk_bf16_f32 v65, v38, v39
    v_exp_f32 v41, v41
    v_exp_f32 v42, v42
    v_exp_f32 v43, v43
    v_cvt_pk_bf16_f32 v66, v40, v41
    v_cvt_pk_bf16_f32 v67, v42, v43
    s_setprio 0
    ds_read_b128 v[92:95], v98 offset:512
    ds_read_b128 v[84:87], v96 offset:20480
    ds_read_b128 v[88:91], v98 offset:2048
    s_add_u32 m0, s39, 49152
    s_nop 0
    buffer_load_dwordx4 v101, s[8:11], s35 offen offset:1024 sc1 lds
    s_add_u32 s35, s35, 8192
    s_cmp_eq_u32 s35, s36
    s_cselect_b32 s35, s37, s35
    s_waitcnt lgkmcnt(0)
    v_exp_f32 v44, v44
    v_exp_f32 v45, v45
    v_mfma_f32_32x32x16_bf16 v[68:83], v[92:95], v[64:67], v[68:83]
    s_setprio 1
    v_exp_f32 v46, v46
    v_cvt_pk_bf16_f32 v60, v44, v45
    v_exp_f32 v47, v47
    v_exp_f32 v48, v48
    v_cvt_pk_bf16_f32 v61, v46, v47
    v_exp_f32 v49, v49
    v_exp_f32 v50, v50
    v_mfma_f32_32x32x16_bf16 v[28:43], v[84:87], v[116:119], v[12:27]
    v_cvt_pk_bf16_f32 v62, v48, v49
    v_exp_f32 v51, v51
    v_exp_f32 v52, v52
    v_cvt_pk_bf16_f32 v63, v50, v51
    v_exp_f32 v53, v53
    v_exp_f32 v54, v54
    v_mfma_f32_32x32x16_bf16 v[68:83], v[88:91], v[60:63], v[68:83]
    v_cvt_pk_bf16_f32 v64, v52, v53
    v_exp_f32 v55, v55
    v_exp_f32 v56, v56
    v_cvt_pk_bf16_f32 v65, v54, v55
    v_exp_f32 v57, v57
    v_exp_f32 v58, v58
    v_exp_f32 v59, v59
    v_cvt_pk_bf16_f32 v66, v56, v57
    v_cvt_pk_bf16_f32 v67, v58, v59
    s_setprio 0
    ds_read_b128 v[92:95], v98 offset:2560
    ds_read_b128 v[84:87], v96 offset:22528
    ds_read_b128 v[88:91], v98 offset:4096
    s_waitcnt vmcnt(2) lgkmcnt(0)
    s_barrier
    v_exp_f32 v28, v28
    v_exp_f32 v29, v29
    v_mfma_f32_32x32x16_bf16 v[68:83], v[92:95], v[64:67], v[68:83]
    s_setprio 1
    v_exp_f32 v30, v30
    v_cvt_pk_bf16_f32 v60, v28, v29
    v_exp_f32 v31, v31
    v_exp_f32 v32, v32
    v_cvt_pk_bf16_f32 v61, v30, v31
    v_exp_f32 v33, v33
    v_exp_f32 v34, v34
    v_mfma_f32_32x32x16_bf16 v[44:59], v[84:87], v[116:119], v[12:27]
    v_cvt_pk_bf16_f32 v62, v32, v33
    v_exp_f32 v35, v35
    v_exp_f32 v36, v36
    v_cvt_pk_bf16_f32 v63, v34, v35
    v_exp_f32 v37, v37
    v_exp_f32 v38, v38
    v_mfma_f32_32x32x16_bf16 v[68:83], v[88:91], v[60:63], v[68:83]
    v_cvt_pk_bf16_f32 v64, v36, v37
    v_exp_f32 v39, v39
    v_exp_f32 v40, v40
    v_cvt_pk_bf16_f32 v65, v38, v39
    v_exp_f32 v41, v41
    v_exp_f32 v42, v42
    v_exp_f32 v43, v43
    v_cvt_pk_bf16_f32 v66, v40, v41
    v_cvt_pk_bf16_f32 v67, v42, v43
    s_setprio 0
    ds_read_b128 v[92:95], v98 offset:4608
    ds_read_b128 v[84:87], v96 offset:32768
    ds_read_b128 v[88:91], v98 offset:6144
    s_add_u32 m0, s39, 0
    s_nop 0
    buffer_load_dwordx4 v101, s[8:11], s35 offen sc1 lds
    s_waitcnt lgkmcnt(0)
    v_exp_f32 v44, v44
    v_exp_f32 v45, v45
    v_mfma_f32_32x32x16_bf16 v[68:83], v[92:95], v[64:67], v[68:83]
    s_setprio 1
    v_exp_f32 v46, v46
    v_cvt_pk_bf16_f32 v60, v44, v45
    v_exp_f32 v47, v47
    v_exp_f32 v48, v48
    v_cvt_pk_bf16_f32 v61, v46, v47
    v_exp_f32 v49, v49
    v_exp_f32 v50, v50
    v_mfma_f32_32x32x16_bf16 v[28:43], v[84:87], v[116:119], v[12:27]
    v_cvt_pk_bf16_f32 v62, v48, v49
    v_exp_f32 v51, v51
    v_exp_f32 v52, v52
    v_cvt_pk_bf16_f32 v63, v50, v51
    v_exp_f32 v53, v53
    v_exp_f32 v54, v54
    v_mfma_f32_32x32x16_bf16 v[68:83], v[88:91], v[60:63], v[68:83]
    v_cvt_pk_bf16_f32 v64, v52, v53
    v_exp_f32 v55, v55
    v_exp_f32 v56, v56
    v_cvt_pk_bf16_f32 v65, v54, v55
    v_exp_f32 v57, v57
    v_exp_f32 v58, v58
    v_exp_f32 v59, v59
    v_cvt_pk_bf16_f32 v66, v56, v57
    v_cvt_pk_bf16_f32 v67, v58, v59
    s_setprio 0
    ds_read_b128 v[92:95], v98 offset:6656
    ds_read_b128 v[84:87], v96 offset:34816
    ds_read_b128 v[88:91], v99 offset:0
    s_bitcmp1_b32 s98, s57
    s_cselect_b64 exec, -1, 0
    s_cselect_b32 s40, 1024, 0
    s_mov_b32 m0, s26
    s_add_u32 s26, s26, s40
    s_lshl_b32 s40, s40, 3
    buffer_load_dwordx4 v126, s[68:71], s27 offen lds
    s_add_u32 s27, s27, s40
    s_mov_b64 exec, -1
    s_waitcnt lgkmcnt(0)
    v_exp_f32 v28, v28
    v_exp_f32 v29, v29
    v_mfma_f32_32x32x16_bf16 v[68:83], v[92:95], v[64:67], v[68:83]
    s_setprio 1
    v_exp_f32 v30, v30
    v_cvt_pk_bf16_f32 v60, v28, v29
    v_exp_f32 v31, v31
    v_exp_f32 v32, v32
    v_cvt_pk_bf16_f32 v61, v30, v31
    v_exp_f32 v33, v33
    v_exp_f32 v34, v34
    v_mfma_f32_32x32x16_bf16 v[44:59], v[84:87], v[116:119], v[12:27]
    v_cvt_pk_bf16_f32 v62, v32, v33
    v_exp_f32 v35, v35
    v_exp_f32 v36, v36
    v_cvt_pk_bf16_f32 v63, v34, v35
    v_exp_f32 v37, v37
    v_exp_f32 v38, v38
    v_mfma_f32_32x32x16_bf16 v[68:83], v[88:91], v[60:63], v[68:83]
    v_cvt_pk_bf16_f32 v64, v36, v37
    v_exp_f32 v39, v39
    v_exp_f32 v40, v40
    v_cvt_pk_bf16_f32 v65, v38, v39
    v_exp_f32 v41, v41
    v_exp_f32 v42, v42
    v_exp_f32 v43, v43
    v_cvt_pk_bf16_f32 v66, v40, v41
    v_cvt_pk_bf16_f32 v67, v42, v43
    s_setprio 0
    ds_read_b128 v[92:95], v99 offset:512
    ds_read_b128 v[84:87], v96 offset:36864
    ds_read_b128 v[88:91], v99 offset:2048
    s_add_u32 m0, s39, 0
    s_nop 0
    buffer_load_dwordx4 v101, s[8:11], s35 offen offset:1024 sc1 lds
    s_add_u32 s35, s35, 8192
    s_cmp_eq_u32 s35, s36
    s_cselect_b32 s35, s37, s35
    s_waitcnt lgkmcnt(0)
    v_exp_f32 v44, v44
    v_exp_f32 v45, v45
    v_mfma_f32_32x32x16_bf16 v[68:83], v[92:95], v[64:67], v[68:83]
    s_setprio 1
    v_exp_f32 v46, v46
    v_cvt_pk_bf16_f32 v60, v44, v45
    v_exp_f32 v47, v47
    v_exp_f32 v48, v48
    v_cvt_pk_bf16_f32 v61, v46, v47
    v_exp_f32 v49, v49
    v_exp_f32 v50, v50
    v_mfma_f32_32x32x16_bf16 v[28:43], v[84:87], v[116:119], v[12:27]
    v_cvt_pk_bf16_f32 v62, v48, v49
    v_exp_f32 v51, v51
    v_exp_f32 v52, v52
    v_cvt_pk_bf16_f32 v63, v50, v51
    v_exp_f32 v53, v53
    v_exp_f32 v54, v54
    v_mfma_f32_32x32x16_bf16 v[68:83], v[88:91], v[60:63], v[68:83]
    v_cvt_pk_bf16_f32 v64, v52, v53
    v_exp_f32 v55, v55
    v_exp_f32 v56, v56
    v_cvt_pk_bf16_f32 v65, v54, v55
    v_exp_f32 v57, v57
    v_exp_f32 v58, v58
    v_exp_f32 v59, v59
    v_cvt_pk_bf16_f32 v66, v56, v57
    v_cvt_pk_bf16_f32 v67, v58, v59
    s_setprio 0
    ds_read_b128 v[92:95], v99 offset:2560
    ds_read_b128 v[84:87], v96 offset:38912
    ds_read_b128 v[88:91], v99 offset:4096
    s_waitcnt vmcnt(2) lgkmcnt(0)
    s_barrier
    v_exp_f32 v28, v28
    v_exp_f32 v29, v29
    v_mfma_f32_32x32x16_bf16 v[68:83], v[92:95], v[64:67], v[68:83]
    s_setprio 1
    v_exp_f32 v30, v30
    v_cvt_pk_bf16_f32 v60, v28, v29
    v_exp_f32 v31, v31
    v_exp_f32 v32, v32
    v_cvt_pk_bf16_f32 v61, v30, v31
    v_exp_f32 v33, v33
    v_exp_f32 v34, v34
    v_mfma_f32_32x32x16_bf16 v[44:59], v[84:87], v[116:119], v[12:27]
    v_cvt_pk_bf16_f32 v62, v32, v33
    v_exp_f32 v35, v35
    v_exp_f32 v36, v36
    v_cvt_pk_bf16_f32 v63, v34, v35
    v_exp_f32 v37, v37
    v_exp_f32 v38, v38
    v_mfma_f32_32x32x16_bf16 v[68:83], v[88:91], v[60:63], v[68:83]
    v_cvt_pk_bf16_f32 v64, v36, v37
    v_exp_f32 v39, v39
    v_exp_f32 v40, v40
    v_cvt_pk_bf16_f32 v65, v38, v39
    v_exp_f32 v41, v41
    v_exp_f32 v42, v42
    v_exp_f32 v43, v43
    v_cvt_pk_bf16_f32 v66, v40, v41
    v_cvt_pk_bf16_f32 v67, v42, v43
    s_setprio 0
    ds_read_b128 v[92:95], v99 offset:4608
    ds_read_b128 v[84:87], v96 offset:49152
    ds_read_b128 v[88:91], v99 offset:6144
    s_add_u32 m0, s39, 16384
    s_nop 0
    buffer_load_dwordx4 v101, s[8:11], s35 offen sc1 lds
    s_waitcnt lgkmcnt(0)
    v_exp_f32 v44, v44
    v_exp_f32 v45, v45
    v_mfma_f32_32x32x16_bf16 v[68:83], v[92:95], v[64:67], v[68:83]
    s_setprio 1
    v_exp_f32 v46, v46
    v_cvt_pk_bf16_f32 v60, v44, v45
    v_exp_f32 v47, v47
    v_exp_f32 v48, v48
    v_cvt_pk_bf16_f32 v61, v46, v47
    v_exp_f32 v49, v49
    v_exp_f32 v50, v50
    v_mfma_f32_32x32x16_bf16 v[28:43], v[84:87], v[116:119], v[12:27]
    v_cvt_pk_bf16_f32 v62, v48, v49
    v_exp_f32 v51, v51
    v_exp_f32 v52, v52
    v_cvt_pk_bf16_f32 v63, v50, v51
    v_exp_f32 v53, v53
    v_exp_f32 v54, v54
    v_mfma_f32_32x32x16_bf16 v[68:83], v[88:91], v[60:63], v[68:83]
    v_cvt_pk_bf16_f32 v64, v52, v53
    v_exp_f32 v55, v55
    v_exp_f32 v56, v56
    v_cvt_pk_bf16_f32 v65, v54, v55
    v_exp_f32 v57, v57
    v_exp_f32 v58, v58
    v_exp_f32 v59, v59
    v_cvt_pk_bf16_f32 v66, v56, v57
    v_cvt_pk_bf16_f32 v67, v58, v59
    s_setprio 0
    ds_read_b128 v[92:95], v99 offset:6656
    ds_read_b128 v[84:87], v96 offset:51200
    ds_read_b128 v[88:91], v100 offset:0
    s_bitcmp1_b32 s99, s57
    s_cselect_b64 exec, -1, 0
    s_cselect_b32 s40, 1024, 0
    s_mov_b32 m0, s26
    s_add_u32 s26, s26, s40
    s_lshl_b32 s40, s40, 3
    buffer_load_dwordx4 v126, s[68:71], s27 offen lds
    s_add_u32 s27, s27, s40
    s_mov_b64 exec, -1
    s_waitcnt lgkmcnt(0)
    v_exp_f32 v28, v28
    v_exp_f32 v29, v29
    v_mfma_f32_32x32x16_bf16 v[68:83], v[92:95], v[64:67], v[68:83]
    s_setprio 1
    v_exp_f32 v30, v30
    v_cvt_pk_bf16_f32 v60, v28, v29
    v_exp_f32 v31, v31
    v_exp_f32 v32, v32
    v_cvt_pk_bf16_f32 v61, v30, v31
    v_exp_f32 v33, v33
    v_exp_f32 v34, v34
    v_mfma_f32_32x32x16_bf16 v[44:59], v[84:87], v[116:119], v[12:27]
    v_cvt_pk_bf16_f32 v62, v32, v33
    v_exp_f32 v35, v35
    v_exp_f32 v36, v36
    v_cvt_pk_bf16_f32 v63, v34, v35
    v_exp_f32 v37, v37
    v_exp_f32 v38, v38
    v_mfma_f32_32x32x16_bf16 v[68:83], v[88:91], v[60:63], v[68:83]
    v_cvt_pk_bf16_f32 v64, v36, v37
    v_exp_f32 v39, v39
    v_exp_f32 v40, v40
    v_cvt_pk_bf16_f32 v65, v38, v39
    v_exp_f32 v41, v41
    v_exp_f32 v42, v42
    v_exp_f32 v43, v43
    v_cvt_pk_bf16_f32 v66, v40, v41
    v_cvt_pk_bf16_f32 v67, v42, v43
    s_setprio 0
    ds_read_b128 v[92:95], v100 offset:512
    ds_read_b128 v[84:87], v96 offset:53248
    ds_read_b128 v[88:91], v100 offset:2048
    s_add_u32 m0, s39, 16384
    s_nop 0
    buffer_load_dwordx4 v101, s[8:11], s35 offen offset:1024 sc1 lds
    s_add_u32 s35, s35, 8192
    s_cmp_eq_u32 s35, s36
    s_cselect_b32 s35, s37, s35
    s_waitcnt lgkmcnt(0)
    v_exp_f32 v44, v44
    v_exp_f32 v45, v45
    v_mfma_f32_32x32x16_bf16 v[68:83], v[92:95], v[64:67], v[68:83]
    s_setprio 1
    v_exp_f32 v46, v46
    v_cvt_pk_bf16_f32 v60, v44, v45
    v_exp_f32 v47, v47
    v_exp_f32 v48, v48
    v_cvt_pk_bf16_f32 v61, v46, v47
    v_exp_f32 v49, v49
    v_exp_f32 v50, v50
    v_mfma_f32_32x32x16_bf16 v[28:43], v[84:87], v[116:119], v[12:27]
    v_cvt_pk_bf16_f32 v62, v48, v49
    v_exp_f32 v51, v51
    v_exp_f32 v52, v52
    v_cvt_pk_bf16_f32 v63, v50, v51
    v_exp_f32 v53, v53
    v_exp_f32 v54, v54
    v_mfma_f32_32x32x16_bf16 v[68:83], v[88:91], v[60:63], v[68:83]
    v_cvt_pk_bf16_f32 v64, v52, v53
    v_exp_f32 v55, v55
    v_exp_f32 v56, v56
    v_cvt_pk_bf16_f32 v65, v54, v55
    v_exp_f32 v57, v57
    v_exp_f32 v58, v58
    v_exp_f32 v59, v59
    v_cvt_pk_bf16_f32 v66, v56, v57
    v_cvt_pk_bf16_f32 v67, v58, v59
    s_setprio 0
    ds_read_b128 v[92:95], v100 offset:2560
    ds_read_b128 v[84:87], v96 offset:55296
    ds_read_b128 v[88:91], v100 offset:4096
    s_waitcnt vmcnt(2) lgkmcnt(0)
    s_barrier
    v_exp_f32 v28, v28
    v_exp_f32 v29, v29
    v_mfma_f32_32x32x16_bf16 v[68:83], v[92:95], v[64:67], v[68:83]
    s_setprio 1
    v_exp_f32 v30, v30
    v_cvt_pk_bf16_f32 v60, v28, v29
    v_exp_f32 v31, v31
    v_exp_f32 v32, v32
    v_cvt_pk_bf16_f32 v61, v30, v31
    v_exp_f32 v33, v33
    v_exp_f32 v34, v34
    v_mfma_f32_32x32x16_bf16 v[44:59], v[84:87], v[116:119], v[12:27]
    v_cvt_pk_bf16_f32 v62, v32, v33
    v_exp_f32 v35, v35
    v_exp_f32 v36, v36
    v_cvt_pk_bf16_f32 v63, v34, v35
    v_exp_f32 v37, v37
    v_exp_f32 v38, v38
    v_mfma_f32_32x32x16_bf16 v[68:83], v[88:91], v[60:63], v[68:83]
    v_cvt_pk_bf16_f32 v64, v36, v37
    v_exp_f32 v39, v39
    v_exp_f32 v40, v40
    v_cvt_pk_bf16_f32 v65, v38, v39
    v_exp_f32 v41, v41
    v_exp_f32 v42, v42
    v_exp_f32 v43, v43
    v_cvt_pk_bf16_f32 v66, v40, v41
    v_cvt_pk_bf16_f32 v67, v42, v43
    s_setprio 0
    ds_read_b128 v[92:95], v100 offset:4608
    ds_read_b128 v[84:87], v96 offset:0
    ds_read_b128 v[88:91], v100 offset:6144
    s_add_u32 m0, s39, 32768
    s_nop 0
    buffer_load_dwordx4 v101, s[8:11], s35 offen sc1 lds
    s_waitcnt lgkmcnt(0)
    v_exp_f32 v44, v44
    v_exp_f32 v45, v45
    v_mfma_f32_32x32x16_bf16 v[68:83], v[92:95], v[64:67], v[68:83]
    s_setprio 1
    v_exp_f32 v46, v46
    v_cvt_pk_bf16_f32 v60, v44, v45
    v_exp_f32 v47, v47
    v_exp_f32 v48, v48
    v_cvt_pk_bf16_f32 v61, v46, v47
    v_exp_f32 v49, v49
    v_exp_f32 v50, v50
    v_mfma_f32_32x32x16_bf16 v[28:43], v[84:87], v[116:119], v[12:27]
    v_cvt_pk_bf16_f32 v62, v48, v49
    v_exp_f32 v51, v51
    v_exp_f32 v52, v52
    v_cvt_pk_bf16_f32 v63, v50, v51
    v_exp_f32 v53, v53
    v_exp_f32 v54, v54
    v_mfma_f32_32x32x16_bf16 v[68:83], v[88:91], v[60:63], v[68:83]
    v_cvt_pk_bf16_f32 v64, v52, v53
    v_exp_f32 v55, v55
    v_exp_f32 v56, v56
    v_cvt_pk_bf16_f32 v65, v54, v55
    v_exp_f32 v57, v57
    v_exp_f32 v58, v58
    v_exp_f32 v59, v59
    v_cvt_pk_bf16_f32 v66, v56, v57
    v_cvt_pk_bf16_f32 v67, v58, v59
    s_setprio 0
    ds_read_b128 v[92:95], v100 offset:6656
    ds_read_b128 v[84:87], v96 offset:2048
    ds_read_b128 v[88:91], v97 offset:0
    s_add_u32 s57, s57, 1
    s_bitcmp1_b32 s58, s57
    s_cselect_b32 s40, 1, 0
    s_or_b32 s40, s40, vcc_lo
    s_cbranch_scc0 L_loop_Y
    s_cmp_eq_u32 s57, 4
    s_cbranch_scc0 L_sp_Y
    ds_read_b128 v[44:47], v96 offset:0
    s_waitcnt lgkmcnt(1)
    v_mfma_f32_32x32x16_bf16 v[68:83], v[92:95], v[64:67], v[68:83]
    s_waitcnt lgkmcnt(0)
    v_mfma_f32_32x32x16_bf16 v[28:43], v[44:47], v[120:123], 0
    s_nop 7
    s_nop 4
    v_mov_b32 v112, v76
    v_mov_b32 v113, v76
    v_max3_f32 v106, abs(v68), abs(v69), abs(v70)
    v_max3_f32 v107, abs(v71), abs(v72), abs(v73)
    v_permlane32_swap_b32 v112, v113
    v_max3_f32 v106, v106, abs(v74), abs(v75)
    v_mov_b32 v108, 0x79000000
    v_max_f32 v106, v106, v107
    v_cmp_nle_f32 s[42:43], v112, v108
    v_mul_f32 v107, 0x3b800000, v106
    v_cmp_nle_f32 vcc, v107, v108
    v_rcp_f32 v106, v112
    s_nop 3
    s_or_b64 vcc, vcc, s[42:43]
    s_cbranch_vccnz L_slow
L_normB_Y:
    v_mul_f32 v106, v106, v102
    v_mul_f32 v68, v68, v106
    v_mul_f32 v69, v69, v106
    v_mul_f32 v70, v70, v106
    v_mul_f32 v71, v71, v106
    v_mul_f32 v72, v72, v106
    v_mul_f32 v73, v73, v106
    v_mul_f32 v74, v74, v106
    v_mul_f32 v75, v75, v106
    v_cvt_pk_bf16_f32 v60, v68, v69
    v_cvt_pk_bf16_f32 v61, v70, v71
    v_cvt_pk_bf16_f32 v62, v72, v73
    v_cvt_pk_bf16_f32 v63, v74, v75
    buffer_store_dwordx4 v[60:63], v104, s[8:11], s50 offen sc1
    v_mov_b32 v64, 0
    v_mov_b32 v65, 0
    v_mov_b32 v66, 0
    v_mov_b32 v67, 0
    v_max3_f32 v106, v28, v29, v30
    v_max3_f32 v107, v31, v32, v33
    v_max3_f32 v108, v34, v35, v36
    v_max3_f32 v109, v37, v38, v39
    v_max3_f32 v106, v106, v40, v41
    v_max3_f32 v107, v107, v42, v43
    v_max3_f32 v106, v106, v108, v109
    v_mfma_f32_32x32x16_bf16 v[68:83], v[92:95], v[64:67], 0
    v_max_f32 v106, v106, v107
    s_nop 0
    v_mov_b32 v107, v106
    s_nop 1
    v_permlane32_swap_b32 v106, v107
    s_nop 0
    v_max_f32 v106, v106, v107
    v_add_f32 v106, 0x42c80000, v106
    v_sub_f32 v12, 0, v106
    v_sub_f32 v13, 0, v106
    v_sub_f32 v14, 0, v106
    v_sub_f32 v15, 0, v106
    v_sub_f32 v16, 0, v106
    v_sub_f32 v17, 0, v106
    v_sub_f32 v18, 0, v106
    v_sub_f32 v19, 0, v106
    v_sub_f32 v20, 0, v106
    v_sub_f32 v21, 0, v106
    v_sub_f32 v22, 0, v106
    v_sub_f32 v23, 0, v106
    v_sub_f32 v24, 0, v106
    v_sub_f32 v25, 0, v106
    v_sub_f32 v26, 0, v106
    v_sub_f32 v27, 0, v106
    s_nop 1
    v_mfma_f32_32x32x16_bf16 v[28:43], v[44:47], v[120:123], v[12:27]
    v_mov_b32 v116, v120
    v_mov_b32 v117, v121
    v_mov_b32 v118, v122
    v_mov_b32 v119, v123
    v_mov_b32 v102, v103
    s_add_u32 s50, s50, 2097152
    s_mov_b32 s51, s37
    s_mov_b32 s49, 1
    s_mov_b32 s12, s76
    s_mov_b32 s13, s77
    s_mov_b32 s14, s78
    s_mov_b32 s15, s79
    s_lshl_b32 s96, s28, 7
    s_lshl_b32 s41, s29, 3
    s_add_u32 s96, s96, s41
    s_add_u32 s96, s96, 15736832
    s_lshr_b32 s97, s66, 1
    s_lshl_b32 s97, s97, 7
    s_add_u32 s97, s97, 15736832
    s_mov_b64 vcc, 0
    s_branch L_loop_Y
L_redoT_Y:
    ds_read_b128 v[44:47], v96 offset:0
    ds_read_b128 v[84:87], v96 offset:2048
    s_waitcnt lgkmcnt(0)
    v_mfma_f32_32x32x16_bf16 v[28:43], v[44:47], v[120:123], 0
    s_nop 7
    s_nop 7
    s_branch L_normB_Y
L_sp_Y:
    s_waitcnt lgkmcnt(0)
    v_mfma_f32_32x32x16_bf16 v[68:83], v[92:95], v[64:67], v[68:83]
    s_nop 7
    s_nop 7
    v_mov_b32 v112, v76
    v_mov_b32 v113, v76
    v_max3_f32 v106, abs(v68), abs(v69), abs(v70)
    v_max3_f32 v107, abs(v71), abs(v72), abs(v73)
    v_permlane32_swap_b32 v112, v113
    v_max3_f32 v106, v106, abs(v74), abs(v75)
    v_mov_b32 v108, 0x79000000
    v_max_f32 v106, v106, v107
    v_cmp_nle_f32 s[42:43], v112, v108
    v_mul_f32 v107, 0x3b800000, v106
    v_cmp_nle_f32 vcc, v107, v108
    v_rcp_f32 v106, v112
    s_nop 3
    s_or_b64 vcc, vcc, s[42:43]
    s_cbranch_vccnz L_slow
L_normA_Y:
    v_mul_f32 v106, v106, v102
    v_mul_f32 v68, v68, v106
    v_mul_f32 v69, v69, v106
    v_mul_f32 v70, v70, v106
    v_mul_f32 v71, v71, v106
    v_mul_f32 v72, v72, v106
    v_mul_f32 v73, v73, v106
    v_mul_f32 v74, v74, v106
    v_mul_f32 v75, v75, v106
    v_cvt_pk_bf16_f32 v60, v68, v69
    v_cvt_pk_bf16_f32 v61, v70, v71
    v_cvt_pk_bf16_f32 v62, v72, v73
    v_cvt_pk_bf16_f32 v63, v74, v75
    buffer_store_dwordx4 v[60:63], v104, s[8:11], s50 offen sc1
    s_branch L_attn_done
L_slow:
    v_lshlrev_b32 v109, 4, v1
    v_and_b32 v111, 15, v1
    v_lshrrev_b32 v110, 5, v1
    v_lshlrev_b32 v110, 8, v110
    v_lshl_add_u32 v110, v111, 4, v110
    v_mov_b32 v106, 0xff800000
    s_mov_b32 s41, 0
L_slow1:
    s_add_u32 s46, s41, s51
    buffer_load_dwordx4 v[84:87], v109, s[8:11], s46 offen sc1
    s_waitcnt vmcnt(0)
    v_mfma_f32_32x32x16_bf16 v[28:43], v[84:87], v[116:119], 0
    s_nop 7
    s_nop 7
    v_max3_f32 v106, v106, v28, v29
    v_max3_f32 v106, v106, v30, v31
    v_max3_f32 v106, v106, v32, v33
    v_max3_f32 v106, v106, v34, v35
    v_max3_f32 v106, v106, v36, v37
    v_max3_f32 v106, v106, v38, v39
    v_max3_f32 v106, v106, v40, v41
    v_max3_f32 v106, v106, v42, v43
    s_add_u32 s41, s41, 2048
    s_cmp_lt_u32 s41, 131072
    s_cbranch_scc1 L_slow1
    v_mov_b32 v107, v106
    s_nop 1
    v_permlane32_swap_b32 v106, v107
    s_nop 1
    v_max_f32 v106, v106, v107
    v_sub_f32 v12, 0, v106
    v_mov_b32 v68, 0
    v_sub_f32 v13, 0, v106
    v_mov_b32 v69, 0
    v_sub_f32 v14, 0, v106
    v_mov_b32 v70, 0
    v_sub_f32 v15, 0, v106
    v_mov_b32 v71, 0
    v_sub_f32 v16, 0, v106
    v_mov_b32 v72, 0
    v_sub_f32 v17, 0, v106
    v_mov_b32 v73, 0
    v_sub_f32 v18, 0, v106
    v_mov_b32 v74, 0
    v_sub_f32 v19, 0, v106
    v_mov_b32 v75, 0
    v_sub_f32 v20, 0, v106
    v_mov_b32 v76, 0
    v_sub_f32 v21, 0, v106
    v_mov_b32 v77, 0
    v_sub_f32 v22, 0, v106
    v_mov_b32 v78, 0
    v_sub_f32 v23, 0, v106
    v_mov_b32 v79, 0
    v_sub_f32 v24, 0, v106
    v_mov_b32 v80, 0
    v_sub_f32 v25, 0, v106
    v_mov_b32 v81, 0
    v_sub_f32 v26, 0, v106
    v_mov_b32 v82, 0
    v_sub_f32 v27, 0, v106
    v_mov_b32 v83, 0
    v_mov_b32 v44, 0x3f803f80
    v_mov_b32 v45, 0x3f803f80
    v_mov_b32 v46, 0x3f803f80
    v_mov_b32 v47, 0x3f803f80
    v_mov_b32 v48, 0x3f803f80
    v_mov_b32 v49, 0x3f803f80
    v_mov_b32 v50, 0x3f803f80
    v_mov_b32 v51, 0x3f803f80
    s_mov_b32 s41, 0
L_slow2:
    s_add_u32 s46, s41, s51
    buffer_load_dwordx4 v[84:87], v109, s[8:11], s46 offen sc1
    s_mov_b32 exec_lo, 0xffff
    s_mov_b32 exec_hi, 0xffff
    buffer_load_dwordx4 v[44:47], v110, s[8:11], s46 offen offset:1024 sc1
    buffer_load_dwordx4 v[48:51], v110, s[8:11], s46 offen offset:1536 sc1
    s_mov_b64 exec, -1
    s_waitcnt vmcnt(0)
    s_nop 3
    v_mfma_f32_32x32x16_bf16 v[28:43], v[84:87], v[116:119], v[12:27]
    s_nop 7
    s_nop 7
    v_exp_f32 v28, v28
    v_exp_f32 v29, v29
    v_exp_f32 v30, v30
    v_exp_f32 v31, v31
    v_exp_f32 v32, v32
    v_exp_f32 v33, v33
    v_exp_f32 v34, v34
    v_exp_f32 v35, v35
    v_exp_f32 v36, v36
    v_exp_f32 v37, v37
    v_exp_f32 v38, v38
    v_exp_f32 v39, v39
    v_exp_f32 v40, v40
    v_exp_f32 v41, v41
    v_exp_f32 v42, v42
    v_exp_f32 v43, v43
    s_nop 0
    v_cvt_pk_bf16_f32 v60, v28, v29
    v_cvt_pk_bf16_f32 v61, v30, v31
    v_cvt_pk_bf16_f32 v62, v32, v33
    v_cvt_pk_bf16_f32 v63, v34, v35
    v_cvt_pk_bf16_f32 v64, v36, v37
    v_cvt_pk_bf16_f32 v65, v38, v39
    v_cvt_pk_bf16_f32 v66, v40, v41
    v_cvt_pk_bf16_f32 v67, v42, v43
    s_nop 1
    v_mfma_f32_32x32x16_bf16 v[68:83], v[44:47], v[60:63], v[68:83]
    v_mfma_f32_32x32x16_bf16 v[68:83], v[48:51], v[64:67], v[68:83]
    s_add_u32 s41, s41, 2048
    s_cmp_lt_u32 s41, 131072
    s_cbranch_scc1 L_slow2
    s_nop 7
    s_nop 7
    v_rcp_f32 v106, v76
    s_nop 0
    s_lshl_b32 s40, s49, 1
    s_add_u32 s40, s40, s31
    s_cmp_eq_u32 s40, 0
    s_cbranch_scc1 L_redoT_X
    s_cmp_eq_u32 s40, 1
    s_cbranch_scc1 L_redoT_Y
    s_cmp_eq_u32 s40, 2
    s_cbranch_scc1 L_normA_X
    s_branch L_normA_Y
L_attn_done:
    s_setprio 0
    s_waitcnt vmcnt(0)
    s_barrier
    s_cmp_eq_u32 s30, 0
    s_cbranch_scc0 L_t_nopub
    s_lshl_b32 s40, s28, 7
    s_lshl_b32 s41, s29, 3
    s_add_u32 s40, s40, s41
    s_add_u32 s40, s40, 15740928
    v_mov_b32 v106, s52
    v_mov_b32 v107, s53
    v_mov_b32 v108, 0
    s_mov_b64 exec, 1
    buffer_store_dwordx2 v[106:107], v108, s[8:11], s40 offen sc1
    s_mov_b64 exec, -1
L_t_nopub:
    s_mov_b32 s40, 9437184
    buffer_load_dwordx4 a[0:3], v125, s[8:11], s40 offen sc1
    s_mov_b32 s40, 9502720
    buffer_load_dwordx4 a[4:7], v125, s[8:11], s40 offen sc1
    s_mov_b32 s40, 9568256
    buffer_load_dwordx4 a[8:11], v125, s[8:11], s40 offen sc1
    s_mov_b32 s40, 9633792
    buffer_load_dwordx4 a[12:15], v125, s[8:11], s40 offen sc1
    s_mov_b32 s40, 9699328
    buffer_load_dwordx4 a[16:19], v125, s[8:11], s40 offen sc1
    s_mov_b32 s40, 9764864
    buffer_load_dwordx4 a[20:23], v125, s[8:11], s40 offen sc1
    s_mov_b32 s40, 9830400
    buffer_load_dwordx4 a[24:27], v125, s[8:11], s40 offen sc1
    s_mov_b32 s40, 9895936
    buffer_load_dwordx4 a[28:31], v125, s[8:11], s40 offen sc1
    s_lshl_b32 s41, s30, 13
    s_lshl_b32 s42, s30, 16
    s_add_u32 m0, s41, 0
    s_add_u32 s40, s42, 0
    buffer_load_dwordx4 v126, s[76:79], s40 offen lds
    s_add_u32 m0, s41, 1024
    s_add_u32 s40, s42, 0
    buffer_load_dwordx4 v127, s[76:79], s40 offen lds
    s_add_u32 m0, s41, 2048
    s_add_u32 s40, s42, 16384
    buffer_load_dwordx4 v126, s[76:79], s40 offen lds
    s_add_u32 m0, s41, 3072
    s_add_u32 s40, s42, 16384
    buffer_load_dwordx4 v127, s[76:79], s40 offen lds
    s_add_u32 m0, s41, 4096
    s_add_u32 s40, s42, 32768
    buffer_load_dwordx4 v126, s[76:79], s40 offen lds
    s_add_u32 m0, s41, 5120
    s_add_u32 s40, s42, 32768
    buffer_load_dwordx4 v127, s[76:79], s40 offen lds
    s_add_u32 m0, s41, 6144
    s_add_u32 s40, s42, 49152
    buffer_load_dwordx4 v126, s[76:79], s40 offen lds
    s_add_u32 m0, s41, 7168
    s_add_u32 s40, s42, 49152
    buffer_load_dwordx4 v127, s[76:79], s40 offen lds
    v_add_u32 v82, 67584, v124
    v_xor_b32 v83, 64, v82
    v_mov_b32 v80, v124
    v_xor_b32 v81, 64, v124
    ds_read_b64_tr_b16 v[44:45], v82 offset:0
    ds_read_b64_tr_b16 v[46:47], v82 offset:1024
    ds_read_b64_tr_b16 v[48:49], v83 offset:0
    ds_read_b64_tr_b16 v[50:51], v83 offset:1024
    ds_read_b64_tr_b16 v[52:53], v82 offset:2048
    ds_read_b64_tr_b16 v[54:55], v82 offset:3072
    ds_read_b64_tr_b16 v[56:57], v83 offset:2048
    ds_read_b64_tr_b16 v[58:59], v83 offset:3072
    ds_read_b64_tr_b16 v[60:61], v82 offset:4096
    ds_read_b64_tr_b16 v[62:63], v82 offset:5120
    ds_read_b64_tr_b16 v[64:65], v83 offset:4096
    ds_read_b64_tr_b16 v[66:67], v83 offset:5120
    ds_read_b64_tr_b16 v[68:69], v82 offset:6144
    ds_read_b64_tr_b16 v[70:71], v82 offset:7168
    ds_read_b64_tr_b16 v[72:73], v83 offset:6144
    ds_read_b64_tr_b16 v[74:75], v83 offset:7168
    s_waitcnt vmcnt(15) lgkmcnt(12)
    v_mfma_f32_32x32x16_bf16 v[12:27], v[44:47], a[0:3], 0
    v_mfma_f32_32x32x16_bf16 v[28:43], v[48:51], a[0:3], 0
    s_waitcnt vmcnt(14) lgkmcnt(8)
    v_mfma_f32_32x32x16_bf16 v[12:27], v[52:55], a[4:7], v[12:27]
    v_mfma_f32_32x32x16_bf16 v[28:43], v[56:59], a[4:7], v[28:43]
    s_waitcnt vmcnt(13) lgkmcnt(4)
    v_mfma_f32_32x32x16_bf16 v[12:27], v[60:63], a[8:11], v[12:27]
    v_mfma_f32_32x32x16_bf16 v[28:43], v[64:67], a[8:11], v[28:43]
    s_waitcnt vmcnt(12) lgkmcnt(0)
    v_mfma_f32_32x32x16_bf16 v[12:27], v[68:71], a[12:15], v[12:27]
    v_mfma_f32_32x32x16_bf16 v[28:43], v[72:75], a[12:15], v[28:43]
    ds_read_b64_tr_b16 v[44:45], v82 offset:8192
    ds_read_b64_tr_b16 v[46:47], v82 offset:9216
    ds_read_b64_tr_b16 v[48:49], v83 offset:8192
    ds_read_b64_tr_b16 v[50:51], v83 offset:9216
    ds_read_b64_tr_b16 v[52:53], v82 offset:10240
    ds_read_b64_tr_b16 v[54:55], v82 offset:11264
    ds_read_b64_tr_b16 v[56:57], v83 offset:10240
    ds_read_b64_tr_b16 v[58:59], v83 offset:11264
    ds_read_b64_tr_b16 v[60:61], v82 offset:12288
    ds_read_b64_tr_b16 v[62:63], v82 offset:13312
    ds_read_b64_tr_b16 v[64:65], v83 offset:12288
    ds_read_b64_tr_b16 v[66:67], v83 offset:13312
    ds_read_b64_tr_b16 v[68:69], v82 offset:14336
    ds_read_b64_tr_b16 v[70:71], v82 offset:15360
    ds_read_b64_tr_b16 v[72:73], v83 offset:14336
    ds_read_b64_tr_b16 v[74:75], v83 offset:15360
    s_waitcnt vmcnt(11) lgkmcnt(12)
    v_mfma_f32_32x32x16_bf16 v[12:27], v[44:47], a[16:19], v[12:27]
    v_mfma_f32_32x32x16_bf16 v[28:43], v[48:51], a[16:19], v[28:43]
    s_waitcnt vmcnt(10) lgkmcnt(8)
    v_mfma_f32_32x32x16_bf16 v[12:27], v[52:55], a[20:23], v[12:27]
    v_mfma_f32_32x32x16_bf16 v[28:43], v[56:59], a[20:23], v[28:43]
    s_waitcnt vmcnt(9) lgkmcnt(4)
    v_mfma_f32_32x32x16_bf16 v[12:27], v[60:63], a[24:27], v[12:27]
    v_mfma_f32_32x32x16_bf16 v[28:43], v[64:67], a[24:27], v[28:43]
    s_waitcnt vmcnt(8) lgkmcnt(0)
    v_mfma_f32_32x32x16_bf16 v[12:27], v[68:71], a[28:31], v[12:27]
    v_mfma_f32_32x32x16_bf16 v[28:43], v[72:75], a[28:31], v[28:43]
    s_waitcnt vmcnt(0)
    s_cmp_eq_u32 s30, 0
    s_cbranch_scc0 L_t_nopoll
    s_lshr_b32 s40, s66, 1
    s_lshl_b32 s40, s40, 7
    s_add_u32 s40, s40, 15740928
    s_mov_b32 s59, 131072
    v_lshlrev_b32 v110, 4, v1
    s_mov_b32 s46, s40
    s_mov_b64 exec, 255
L_poll4:
    buffer_load_dwordx4 v[106:109], v110, s[8:11], s46 offen sc1
    s_waitcnt vmcnt(0)
    v_xor_b32 v106, s52, v106
    v_xor_b32 v107, s53, v107
    v_xor_b32 v108, s52, v108
    v_xor_b32 v109, s53, v109
    v_or3_b32 v106, v106, v107, v108
    v_or_b32 v106, v106, v109
    v_cmp_ne_u32 vcc, 0, v106
    s_nop 4
    s_cbranch_vccz L_poll4_ok
    s_sub_u32 s59, s59, 1
    s_cmp_eq_u32 s59, 0
    s_cbranch_scc1 L_poll4_ok
    s_sleep 1
    s_branch L_poll4
L_poll4_ok:
    s_mov_b64 exec, -1
L_t_nopoll:
    s_barrier
    s_mov_b32 s40, 11534336
    buffer_load_dwordx4 a[0:3], v125, s[8:11], s40 offen sc1
    s_mov_b32 s40, 11599872
    buffer_load_dwordx4 a[4:7], v125, s[8:11], s40 offen sc1
    s_mov_b32 s40, 11665408
    buffer_load_dwordx4 a[8:11], v125, s[8:11], s40 offen sc1
    s_mov_b32 s40, 11730944
    buffer_load_dwordx4 a[12:15], v125, s[8:11], s40 offen sc1
    s_mov_b32 s40, 11796480
    buffer_load_dwordx4 a[16:19], v125, s[8:11], s40 offen sc1
    s_mov_b32 s40, 11862016
    buffer_load_dwordx4 a[20:23], v125, s[8:11], s40 offen sc1
    s_mov_b32 s40, 11927552
    buffer_load_dwordx4 a[24:27], v125, s[8:11], s40 offen sc1
    s_mov_b32 s40, 11993088
    buffer_load_dwordx4 a[28:31], v125, s[8:11], s40 offen sc1
    ds_read_b64_tr_b16 v[44:45], v80 offset:0
    ds_read_b64_tr_b16 v[46:47], v80 offset:1024
    ds_read_b64_tr_b16 v[48:49], v81 offset:0
    ds_read_b64_tr_b16 v[50:51], v81 offset:1024
    ds_read_b64_tr_b16 v[52:53], v80 offset:2048
    ds_read_b64_tr_b16 v[54:55], v80 offset:3072
    ds_read_b64_tr_b16 v[56:57], v81 offset:2048
    ds_read_b64_tr_b16 v[58:59], v81 offset:3072
    ds_read_b64_tr_b16 v[60:61], v80 offset:4096
    ds_read_b64_tr_b16 v[62:63], v80 offset:5120
    ds_read_b64_tr_b16 v[64:65], v81 offset:4096
    ds_read_b64_tr_b16 v[66:67], v81 offset:5120
    ds_read_b64_tr_b16 v[68:69], v80 offset:6144
    ds_read_b64_tr_b16 v[70:71], v80 offset:7168
    ds_read_b64_tr_b16 v[72:73], v81 offset:6144
    ds_read_b64_tr_b16 v[74:75], v81 offset:7168
    s_waitcnt vmcnt(7) lgkmcnt(12)
    v_mfma_f32_32x32x16_bf16 v[12:27], v[44:47], a[0:3], v[12:27]
    v_mfma_f32_32x32x16_bf16 v[28:43], v[48:51], a[0:3], v[28:43]
    s_waitcnt vmcnt(6) lgkmcnt(8)
    v_mfma_f32_32x32x16_bf16 v[12:27], v[52:55], a[4:7], v[12:27]
    v_mfma_f32_32x32x16_bf16 v[28:43], v[56:59], a[4:7], v[28:43]
    s_waitcnt vmcnt(5) lgkmcnt(4)
    v_mfma_f32_32x32x16_bf16 v[12:27], v[60:63], a[8:11], v[12:27]
    v_mfma_f32_32x32x16_bf16 v[28:43], v[64:67], a[8:11], v[28:43]
    s_waitcnt vmcnt(4) lgkmcnt(0)
    v_mfma_f32_32x32x16_bf16 v[12:27], v[68:71], a[12:15], v[12:27]
    v_mfma_f32_32x32x16_bf16 v[28:43], v[72:75], a[12:15], v[28:43]
    ds_read_b64_tr_b16 v[44:45], v80 offset:8192
    ds_read_b64_tr_b16 v[46:47], v80 offset:9216
    ds_read_b64_tr_b16 v[48:49], v81 offset:8192
    ds_read_b64_tr_b16 v[50:51], v81 offset:9216
    ds_read_b64_tr_b16 v[52:53], v80 offset:10240
    ds_read_b64_tr_b16 v[54:55], v80 offset:11264
    ds_read_b64_tr_b16 v[56:57], v81 offset:10240
    ds_read_b64_tr_b16 v[58:59], v81 offset:11264
    ds_read_b64_tr_b16 v[60:61], v80 offset:12288
    ds_read_b64_tr_b16 v[62:63], v80 offset:13312
    ds_read_b64_tr_b16 v[64:65], v81 offset:12288
    ds_read_b64_tr_b16 v[66:67], v81 offset:13312
    ds_read_b64_tr_b16 v[68:69], v80 offset:14336
    ds_read_b64_tr_b16 v[70:71], v80 offset:15360
    ds_read_b64_tr_b16 v[72:73], v81 offset:14336
    ds_read_b64_tr_b16 v[74:75], v81 offset:15360
    s_waitcnt vmcnt(3) lgkmcnt(12)
    v_mfma_f32_32x32x16_bf16 v[12:27], v[44:47], a[16:19], v[12:27]
    v_mfma_f32_32x32x16_bf16 v[28:43], v[48:51], a[16:19], v[28:43]
    s_waitcnt vmcnt(2) lgkmcnt(8)
    v_mfma_f32_32x32x16_bf16 v[12:27], v[52:55], a[20:23], v[12:27]
    v_mfma_f32_32x32x16_bf16 v[28:43], v[56:59], a[20:23], v[28:43]
    s_waitcnt vmcnt(1) lgkmcnt(4)
    v_mfma_f32_32x32x16_bf16 v[12:27], v[60:63], a[24:27], v[12:27]
    v_mfma_f32_32x32x16_bf16 v[28:43], v[64:67], a[24:27], v[28:43]
    s_waitcnt vmcnt(0) lgkmcnt(0)
    v_mfma_f32_32x32x16_bf16 v[12:27], v[68:71], a[28:31], v[12:27]
    v_mfma_f32_32x32x16_bf16 v[28:43], v[72:75], a[28:31], v[28:43]
    s_nop 7
    s_nop 7
    s_and_b32 s40, s30, 1
    s_lshl_b32 s40, s40, 15
    s_add_u32 s40, s40, 67584
    s_lshr_b32 s41, s30, 1
    s_lshl_b32 s42, s41, 11
    s_add_u32 s42, s42, s40
    s_lshl_b32 s43, s41, 13
    s_add_u32 s43, s43, s40
    v_lshlrev_b32 v106, 4, v1
    v_add_u32 v107, s43, v106
    v_add_u32 v106, s42, v106
    ds_write_b128 v106, v[12:15] offset:0
    ds_write_b128 v106, v[16:19] offset:1024
    ds_write_b128 v106, v[20:23] offset:8192
    ds_write_b128 v106, v[24:27] offset:9216
    ds_write_b128 v106, v[28:31] offset:16384
    ds_write_b128 v106, v[32:35] offset:17408
    ds_write_b128 v106, v[36:39] offset:24576
    ds_write_b128 v106, v[40:43] offset:25600
    s_waitcnt lgkmcnt(0)
    s_barrier
    ds_read_b128 v[44:47], v107 offset:0
    ds_read_b128 v[48:51], v107 offset:1024
    ds_read_b128 v[52:55], v107 offset:2048
    ds_read_b128 v[56:59], v107 offset:3072
    ds_read_b128 v[60:63], v107 offset:4096
    ds_read_b128 v[64:67], v107 offset:5120
    ds_read_b128 v[68:71], v107 offset:6144
    ds_read_b128 v[72:75], v107 offset:7168
    s_lshl_b32 s40, s66, 6
    s_and_b32 s42, s30, 1
    s_lshl_b32 s42, s42, 5
    s_add_u32 s40, s40, s42
    v_and_b32 v106, 31, v1
    v_add_u32 v106, s40, v106
    v_lshlrev_b32 v106, 10, v106
    s_lshl_b32 s40, s67, 7
    s_lshl_b32 s41, s41, 5
    s_add_u32 s40, s40, s41
    v_lshrrev_b32 v108, 5, v1
    v_lshl_add_u32 v106, v108, 4, v106
    s_waitcnt lgkmcnt(0)
    v_add_f32 v84, v44, v52
    v_add_f32 v92, v60, v68
    v_add_f32 v85, v45, v53
    v_add_f32 v93, v61, v69
    v_add_f32 v86, v46, v54
    v_add_f32 v94, v62, v70
    v_add_f32 v87, v47, v55
    v_add_f32 v95, v63, v71
    v_add_f32 v88, v48, v56
    v_add_f32 v96, v64, v72
    v_add_f32 v89, v49, v57
    v_add_f32 v97, v65, v73
    v_add_f32 v90, v50, v58
    v_add_f32 v98, v66, v74
    v_add_f32 v91, v51, v59
    v_add_f32 v99, v67, v75
    v_add_f32 v84, v84, v92
    v_add_f32 v85, v85, v93
    v_add_f32 v86, v86, v94
    v_add_f32 v87, v87, v95
    v_add_f32 v88, v88, v96
    v_add_f32 v89, v89, v97
    v_add_f32 v90, v90, v98
    v_add_f32 v91, v91, v99
    v_cvt_pk_bf16_f32 v100, v84, v85
    v_cvt_pk_bf16_f32 v101, v86, v87
    v_cvt_pk_bf16_f32 v102, v88, v89
    v_cvt_pk_bf16_f32 v103, v90, v91
    s_nop 1
    v_permlane32_swap_b32 v100, v102
    v_permlane32_swap_b32 v101, v103
    buffer_store_dwordx4 v[100:103], v106, s[72:75], s40 offen
L_exit:
    s_endpgm
.section .rodata,"a"
.p2align 6
.amdhsa_kernel gated_mix__softmax_full_mha__grouped_kv_mqa__prompt_kernel
    .amdhsa_next_free_vgpr 256
    .amdhsa_next_free_sgpr 102
    .amdhsa_accum_offset 128
    .amdhsa_group_segment_fixed_size 0
    .amdhsa_kernarg_size 96
    .amdhsa_user_sgpr_count 2
    .amdhsa_user_sgpr_kernarg_segment_ptr 1
    .amdhsa_system_sgpr_workgroup_id_x 1
    .amdhsa_float_denorm_mode_32 3
.end_amdhsa_kernel
```
